```python
import torch

def _softmax(x, axis=-1):
    return torch.softmax(x, dim=axis)
def _gelu(x):
    return torch.nn.functional.gelu(x, approximate="tanh")
def _silu(x):
    return torch.nn.functional.silu(x)
def _sigmoid(x):
    return torch.sigmoid(x)
def _layernorm(x, axis=-1, eps=1e-5):
    m = x.mean(dim=axis, keepdim=True)
    v = x.var(dim=axis, keepdim=True, unbiased=False)
    return (x - m) / torch.sqrt(v + eps)
def _scatter_add(tgt, idx, src, axis=0):
    return tgt.clone().index_add_(axis, idx, src)
def _segment_sum(src, seg, n):
    out = torch.zeros((n,) + src.shape[1:], dtype=src.dtype)
    return out.index_add_(0, seg, src)
def _pad(x, pw):
    flat = tuple(v for pair in reversed(pw) for v in pair)
    return torch.nn.functional.pad(x, flat)

kernel_name = 'sequential_preLN__ssm_conv_s4d__geglu_ffn__prompt'

def setup_inputs():

    _w = (lambda a: (lambda t: t.to(torch.bfloat16) if t.is_floating_point() else t)(torch.as_tensor(a)))
    def _A_setup():
        Bsz, L, D, N = 1, 2048, 512, 128
        return {
            "u": _w((lambda *s: torch.randn(*s, dtype=torch.bfloat16) * 0.05)(Bsz, L, D)),
            "log_A_real": _w((lambda *s: torch.randn(*s, dtype=torch.bfloat16) * 6.4)(D, N) * 0.5),
            "A_imag": _w((lambda *s: torch.randn(*s, dtype=torch.bfloat16) * 0.05)(D, N) * 3.14),
            "C_real": _w((lambda *s: torch.randn(*s, dtype=torch.bfloat16) * 0.05)(D, N) / N ** 0.5),
            "C_imag": _w((lambda *s: torch.randn(*s, dtype=torch.bfloat16) * 0.05)(D, N) / N ** 0.5),
            "log_dt": _w((lambda *s: torch.randn(*s, dtype=torch.bfloat16) * 0.05)(D) * 0.5 - 4.0),
            "D_skip": _w((lambda *s: torch.randn(*s, dtype=torch.bfloat16) * 0.05)(D)),
        }
    _A_in = _A_setup()

    def _B_setup():
        B, S, D, F = 1, 2048, 512, 1792
        return {
            "x": _w((lambda *s: torch.randn(*s, dtype=torch.bfloat16) * 0.05)(B, S, D)),
            "w_gate": _w((lambda *s: torch.randn(*s, dtype=torch.bfloat16) * 0.05)(D, F)),
            "w_up": _w((lambda *s: torch.randn(*s, dtype=torch.bfloat16) * 0.05)(D, F)),
            "w_down": _w((lambda *s: torch.randn(*s, dtype=torch.bfloat16) * 0.05)(F, D)),
        }
    _B_in = _B_setup()

    return {
        "A_u": _A_in["u"],
        "A_log_A_real": _A_in["log_A_real"],
        "A_A_imag": _A_in["A_imag"],
        "A_C_real": _A_in["C_real"],
        "A_C_imag": _A_in["C_imag"],
        "A_log_dt": _A_in["log_dt"],
        "A_D_skip": _A_in["D_skip"],
        "B_x": _B_in["x"],
        "B_w_gate": _B_in["w_gate"],
        "B_w_up": _B_in["w_up"],
        "B_w_down": _B_in["w_down"],
    }

def reference(A_u, A_log_A_real, A_A_imag, A_C_real, A_C_imag, A_log_dt, A_D_skip, B_x, B_w_gate, B_w_up, B_w_down):
    def _A_ref(u, log_A_real, A_imag, C_real, C_imag, log_dt, D_skip):
        L = u.shape[1]
        dt = torch.exp(log_dt)
        A = -torch.exp(log_A_real) + 1j * A_imag
        C = (C_real + 1j * C_imag) * dt[:, None]
        pos = (lambda x, dt: x.to(dt))(torch.arange(L), log_dt.dtype)
        P = torch.exp((A * dt[:, None])[:, :, None] * pos[None, None, :])
        K = 2.0 * torch.einsum("dn,dnl->dl", C, P).real
        L2 = 2 * L
        u_t = (lambda x, *d: x.permute(*d))(u, 0, 2, 1)
        Kf = (lambda x, *a, **k: torch.fft.rfft(x.float(), *a, **k))(K, L2)
        Uf = (lambda x, *a, **k: torch.fft.rfft(x.float(), *a, **k))(u_t, L2)
        y = (lambda x, *a, **k: torch.fft.irfft(x, *a, **k).to(torch.bfloat16))(Uf * Kf[None, :, :], L2)[:, :, :L]
        y = (lambda x, *d: x.permute(*d))(y, 0, 2, 1)
        return y + u * D_skip[None, None, :]

    def _B_ref(x, w_gate, w_up, w_down):
        return (_gelu(x @ w_gate) * (x @ w_up)) @ w_down

    x = A_u
    h = x + _A_ref(_layernorm(x, axis=-1), A_log_A_real, A_A_imag, A_C_real, A_C_imag, A_log_dt, A_D_skip)
    h2 = h + _B_ref(_layernorm(h, axis=-1), B_w_gate, B_w_up, B_w_down)
    return h2
```

```asm
; @launch grid=(256,1,1) block=(256,1,1) lds=148480
.amdgcn_target "amdgcn-amd-amdhsa--gfx950"
.text
.globl sequential_preLN__ssm_conv_s4d__geglu_ffn__prompt_kernel
.p2align 8
.type sequential_preLN__ssm_conv_s4d__geglu_ffn__prompt_kernel,@function
sequential_preLN__ssm_conv_s4d__geglu_ffn__prompt_kernel:
    s_cmp_ge_u32 s2, 256
    s_cbranch_scc1 sequential_preLN__ssm_conv_s4d__geglu_ffn__prompt_kernel_end
    s_load_dwordx2 s[4:5], s[0:1], 0
    s_load_dwordx8 s[40:47], s[0:1], 8
    s_load_dwordx2 s[16:17], s[0:1], 104
    s_load_dwordx4 s[48:51], s[0:1], 40
    s_load_dwordx4 s[88:91], s[0:1], 64
    s_load_dwordx2 s[92:93], s[0:1], 80
    s_getpc_b64 s[94:95]
sequential_preLN__ssm_conv_s4d__geglu_ffn__prompt_kernel_pc0:
    s_sub_u32 s94, s94, sequential_preLN__ssm_conv_s4d__geglu_ffn__prompt_kernel_pc0-sequential_preLN__ssm_conv_s4d__geglu_ffn__prompt_kernel
    s_subb_u32 s95, s95, 0
    v_lshlrev_b32 v61, 6, v0
    global_load_dword v62, v61, s[94:95]
    v_add_u32 v61, 0x4000, v61
    v_min_u32 v61, sequential_preLN__ssm_conv_s4d__geglu_ffn__prompt_kernel_last-sequential_preLN__ssm_conv_s4d__geglu_ffn__prompt_kernel-4, v61
    global_load_dword v63, v61, s[94:95]
    v_lshrrev_b32 v2, 6, v0
    v_and_b32 v5, 63, v0
    v_readfirstlane_b32 s18, v2
    s_and_b32 s66, s2, 7
    s_lshr_b32 s67, s2, 5
    s_lshl_b32 s67, s67, 3
    s_add_u32 s66, s66, s67
    v_lshrrev_b32 v2, 3, v0
    s_lshl_b32 s22, s66, 5
    v_add_u32 v1, s22, v2
    v_lshlrev_b32 v1, 10, v1
    v_and_b32 v3, 7, v0
    v_lshlrev_b32 v3, 4, v3
    v_add_u32 v1, v1, v3
    s_lshl_b32 s25, s2, 9
    s_lshl_b32 s26, s18, 7
    s_add_u32 s25, s25, s26
    v_lshlrev_b32 v6, 1, v5
    v_add_u32 v6, s25, v6
    v_xor_b32 v7, 0x80, v6
    s_waitcnt lgkmcnt(0)
    global_load_dwordx4 v[8:11], v1, s[4:5] offset:0
    global_load_dwordx4 v[12:15], v1, s[4:5] offset:128
    global_load_dwordx4 v[16:19], v1, s[4:5] offset:256
    global_load_dwordx4 v[20:23], v1, s[4:5] offset:384
    global_load_dwordx4 v[24:27], v1, s[4:5] offset:512
    global_load_dwordx4 v[28:31], v1, s[4:5] offset:640
    global_load_dwordx4 v[32:35], v1, s[4:5] offset:768
    global_load_dwordx4 v[36:39], v1, s[4:5] offset:896
    global_load_ushort v128, v6, s[40:41]
    global_load_ushort v130, v6, s[44:45]
    global_load_ushort v131, v6, s[46:47]
    global_load_ushort v132, v7, s[44:45]
    global_load_ushort v133, v7, s[46:47]
    global_load_ushort v129, v6, s[42:43]
    s_add_u32 s62, s16, 0xfc0000
    s_addc_u32 s63, s17, 0
    s_load_dword s98, s[62:63], 0
    s_lshl_b32 s64, s2, 2
    s_load_dword s97, s[50:51], s64
    s_load_dword s99, s[48:49], s64
    s_lshr_b32 s67, s2, 3
    s_and_b32 s67, s67, 3
    s_mov_b32 s12, s16
    s_mov_b32 s13, s17
    s_mov_b32 s14, 0x200000
    s_mov_b32 s15, 0x20000
    s_add_u32 s8, s16, 0x200000
    s_addc_u32 s9, s17, 0
    s_mov_b32 s10, 0x200000
    s_mov_b32 s11, 0x20000
    s_add_u32 s52, s16, 0xf80000
    s_addc_u32 s53, s17, 0
    s_mov_b32 s54, 0x9000
    s_mov_b32 s55, 0x20000
    v_mov_b32 v64, 0
    v_mov_b32 v65, 0
    v_mov_b32 v66, 0
    v_mov_b32 v67, 0
    s_lshl_b32 s38, s2, 12
    v_lshlrev_b32 v68, 4, v0
    buffer_store_dwordx4 v[64:67], v68, s[52:55], s38 offen sc1
    v_and_b32 v159, 63, v0
    s_lshr_b32 s19, s18, 1
    s_and_b32 s20, s18, 1
    v_lshrrev_b32 v163, 4, v159
    v_and_b32 v164, 3, v159
    s_lshl_b32 s60, s19, 15
    s_add_u32 s60, s60, 17408
    s_lshl_b32 s61, s20, 12
    s_add_u32 s61, s61, s60
    v_lshlrev_b32 v148, 6, v159
    v_add_u32 v148, s61, v148
    v_bfe_u32 v149, v159, 1, 2
    v_xor_b32 v150, 0, v149
    v_lshl_add_u32 v144, v150, 4, v148
    v_xor_b32 v150, 1, v149
    v_lshl_add_u32 v145, v150, 4, v148
    v_xor_b32 v150, 2, v149
    v_lshl_add_u32 v146, v150, 4, v148
    v_xor_b32 v150, 3, v149
    v_lshl_add_u32 v147, v150, 4, v148
    v_lshrrev_b32 v160, 1, v163
    v_bfe_u32 v161, v159, 2, 2
    v_lshl_add_u32 v160, v160, 3, v161
    v_lshlrev_b32 v160, 6, v160
    v_add_u32 v160, s60, v160
    v_and_b32 v162, 1, v163
    v_lshl_add_u32 v162, v162, 2, v164
    v_lshrrev_b32 v161, 1, v161
    s_mov_b32 s62, 0x55443210
    s_mov_b32 s63, 0x66667766
    s_cmp_eq_u32 s20, 0
    s_cselect_b32 s62, s62, s63
    v_lshlrev_b32 v166, 2, v162
    v_mov_b32 v167, s62
    v_lshrrev_b32 v167, v166, v167
    v_and_b32 v167, 15, v167
    v_lshrrev_b32 v166, 1, v167
    v_and_b32 v165, 1, v167
    v_lshl_add_u32 v165, v165, 3, v160
    v_xor_b32 v166, v166, v161
    v_lshl_add_u32 v148, v166, 4, v165
    v_xor_b32 v166, 2, v166
    v_lshl_add_u32 v149, v166, 4, v165
    v_lshrrev_b32 v166, 1, v162
    v_and_b32 v165, 1, v162
    v_lshl_add_u32 v165, v165, 3, v160
    v_xor_b32 v166, v166, v161
    v_lshl_add_u32 v150, v166, 4, v165
    v_xor_b32 v166, 2, v166
    v_lshl_add_u32 v151, v166, 4, v165
    s_lshr_b32 s19, s18, 1
    s_and_b32 s20, s18, 1
    s_lshl_b32 s21, s2, 1
    s_add_u32 s21, s21, s19
    v_lshlrev_b32 v169, 4, v159
    s_lshl_b32 s25, s21, 12
    s_lshl_b32 s26, s20, 11
    s_add_u32 s25, s25, s26
    s_mul_i32 s27, s19, 4608
    s_add_u32 s27, s27, 116224
    v_and_b32 v170, 15, v159
    v_lshrrev_b32 v171, 4, v159
    v_lshlrev_b32 v180, 5, v170
    v_lshl_add_u32 v180, v171, 3, v180
    s_add_u32 s44, s16, 0x200000
    s_addc_u32 s45, s17, 0
    s_mov_b32 s46, 0x200000
    s_mov_b32 s47, 0x20000
    s_mov_b32 s48, s16
    s_mov_b32 s49, s17
    s_mov_b32 s50, 0x200000
    s_mov_b32 s51, 0x20000
    s_add_u32 s52, s16, 0x400000
    s_addc_u32 s53, s17, 0
    s_mov_b32 s54, 0x200000
    s_mov_b32 s55, 0x20000
    v_mov_b32 v174, 0
    v_mov_b32 v175, 0
    v_lshlrev_b32 v173, 3, v159
    v_add_u32 v173, s27, v173
    ds_write_b64 v173, v[174:175]
    s_mul_i32 s30, s19, 16640
    s_add_u32 s30, s30, 82944
    v_bfe_u32 v172, v159, 2, 2
    v_mul_u32_u24 v176, 4160, v172
    v_and_b32 v172, 3, v159
    v_lshlrev_b32 v173, 3, v172
    v_add_u32 v176, v176, v173
    v_lshlrev_b32 v173, 4, v171
    v_sub_u32 v176, v176, v173
    s_lshl_b32 s31, s20, 8
    s_add_u32 s32, s30, s31
    s_add_u32 s32, s32, 88
    v_add_u32 v176, s32, v176
    v_lshlrev_b32 v177, 5, v170
    v_add_u32 v177, v177, v173
    s_sub_u32 s32, s27, s31
    s_add_u32 s32, s32, 288
    v_add_u32 v177, s32, v177
    s_add_u32 s32, s27, s26
    s_add_u32 s32, s32, 512
    v_add_u32 v179, s32, v180
    v_lshlrev_b32 v178, 4, v159
    v_add_u32 v168, s27, v169
    s_add_u32 s33, s26, 512
    v_add_u32 v168, s33, v168
    v_mul_u32_u24 v4, 272, v2
    v_add_u32 v4, v4, v3
    v_and_b32 v5, 63, v0
    v_lshrrev_b32 v6, 6, v0
    v_lshrrev_b32 v7, 4, v5
    v_lshlrev_b32 v40, 3, v7
    v_bfe_u32 v41, v5, 2, 2
    v_add_u32 v40, v40, v41
    v_mul_u32_u24 v40, 272, v40
    v_lshlrev_b32 v41, 6, v6
    v_add_u32 v40, v40, v41
    v_and_b32 v41, 3, v5
    v_lshlrev_b32 v41, 3, v41
    v_add_u32 v40, v40, v41
    v_lshlrev_b32 v41, 5, v6
    v_and_b32 v42, 15, v5
    v_add_u32 v41, v41, v42
    v_lshlrev_b32 v41, 12, v41
    v_lshlrev_b32 v42, 4, v7
    v_add_u32 v41, v41, v42
    s_lshl_b32 s22, s67, 19
    s_lshl_b32 s23, s66, 6
    s_add_u32 s22, s22, s23
    s_add_u32 s23, s22, 0x10000
    s_mov_b32 s32, 0x3f803f80
    v_mov_b32 v44, 0
    v_mov_b32 v45, 0
    v_mov_b32 v46, 0
    v_mov_b32 v47, 0
    s_waitcnt vmcnt(14)
    v_dot2_f32_bf16 v44, v8, s32, v44
    v_dot2_f32_bf16 v46, v8, v8, v46
    v_dot2_f32_bf16 v45, v9, s32, v45
    v_dot2_f32_bf16 v47, v9, v9, v47
    v_dot2_f32_bf16 v44, v10, s32, v44
    v_dot2_f32_bf16 v46, v10, v10, v46
    v_dot2_f32_bf16 v45, v11, s32, v45
    v_dot2_f32_bf16 v47, v11, v11, v47
    s_waitcnt vmcnt(13)
    v_dot2_f32_bf16 v44, v12, s32, v44
    v_dot2_f32_bf16 v46, v12, v12, v46
    v_dot2_f32_bf16 v45, v13, s32, v45
    v_dot2_f32_bf16 v47, v13, v13, v47
    v_dot2_f32_bf16 v44, v14, s32, v44
    v_dot2_f32_bf16 v46, v14, v14, v46
    v_dot2_f32_bf16 v45, v15, s32, v45
    v_dot2_f32_bf16 v47, v15, v15, v47
    s_waitcnt vmcnt(12)
    v_dot2_f32_bf16 v44, v16, s32, v44
    v_dot2_f32_bf16 v46, v16, v16, v46
    v_dot2_f32_bf16 v45, v17, s32, v45
    v_dot2_f32_bf16 v47, v17, v17, v47
    v_dot2_f32_bf16 v44, v18, s32, v44
    v_dot2_f32_bf16 v46, v18, v18, v46
    v_dot2_f32_bf16 v45, v19, s32, v45
    v_dot2_f32_bf16 v47, v19, v19, v47
    s_waitcnt vmcnt(11)
    v_dot2_f32_bf16 v44, v20, s32, v44
    v_dot2_f32_bf16 v46, v20, v20, v46
    v_dot2_f32_bf16 v45, v21, s32, v45
    v_dot2_f32_bf16 v47, v21, v21, v47
    v_dot2_f32_bf16 v44, v22, s32, v44
    v_dot2_f32_bf16 v46, v22, v22, v46
    v_dot2_f32_bf16 v45, v23, s32, v45
    v_dot2_f32_bf16 v47, v23, v23, v47
    s_waitcnt vmcnt(10)
    v_dot2_f32_bf16 v44, v24, s32, v44
    v_dot2_f32_bf16 v46, v24, v24, v46
    v_dot2_f32_bf16 v45, v25, s32, v45
    v_dot2_f32_bf16 v47, v25, v25, v47
    v_dot2_f32_bf16 v44, v26, s32, v44
    v_dot2_f32_bf16 v46, v26, v26, v46
    v_dot2_f32_bf16 v45, v27, s32, v45
    v_dot2_f32_bf16 v47, v27, v27, v47
    s_waitcnt vmcnt(9)
    v_dot2_f32_bf16 v44, v28, s32, v44
    v_dot2_f32_bf16 v46, v28, v28, v46
    v_dot2_f32_bf16 v45, v29, s32, v45
    v_dot2_f32_bf16 v47, v29, v29, v47
    v_dot2_f32_bf16 v44, v30, s32, v44
    v_dot2_f32_bf16 v46, v30, v30, v46
    v_dot2_f32_bf16 v45, v31, s32, v45
    v_dot2_f32_bf16 v47, v31, v31, v47
    s_waitcnt vmcnt(8)
    v_dot2_f32_bf16 v44, v32, s32, v44
    v_dot2_f32_bf16 v46, v32, v32, v46
    v_dot2_f32_bf16 v45, v33, s32, v45
    v_dot2_f32_bf16 v47, v33, v33, v47
    v_dot2_f32_bf16 v44, v34, s32, v44
    v_dot2_f32_bf16 v46, v34, v34, v46
    v_dot2_f32_bf16 v45, v35, s32, v45
    v_dot2_f32_bf16 v47, v35, v35, v47
    s_waitcnt vmcnt(7)
    v_dot2_f32_bf16 v44, v36, s32, v44
    v_dot2_f32_bf16 v46, v36, v36, v46
    v_dot2_f32_bf16 v45, v37, s32, v45
    v_dot2_f32_bf16 v47, v37, v37, v47
    v_dot2_f32_bf16 v44, v38, s32, v44
    v_dot2_f32_bf16 v46, v38, v38, v46
    v_dot2_f32_bf16 v45, v39, s32, v45
    v_dot2_f32_bf16 v47, v39, v39, v47
    s_cmp_eq_u32 s67, 0
    s_cbranch_scc1 sequential_preLN__ssm_conv_s4d__geglu_ffn__prompt_kernel_cq_3
    s_cmp_eq_u32 s67, 1
    s_cbranch_scc1 sequential_preLN__ssm_conv_s4d__geglu_ffn__prompt_kernel_cq_1
    s_cmp_eq_u32 s67, 2
    s_cbranch_scc1 sequential_preLN__ssm_conv_s4d__geglu_ffn__prompt_kernel_cq_2
    v_mov_b32 v8, v32
    v_mov_b32 v9, v33
    v_mov_b32 v10, v34
    v_mov_b32 v11, v35
    v_mov_b32 v12, v36
    v_mov_b32 v13, v37
    v_mov_b32 v14, v38
    v_mov_b32 v15, v39
    s_branch sequential_preLN__ssm_conv_s4d__geglu_ffn__prompt_kernel_cq_3
sequential_preLN__ssm_conv_s4d__geglu_ffn__prompt_kernel_cq_1:
    v_mov_b32 v8, v16
    v_mov_b32 v9, v17
    v_mov_b32 v10, v18
    v_mov_b32 v11, v19
    v_mov_b32 v12, v20
    v_mov_b32 v13, v21
    v_mov_b32 v14, v22
    v_mov_b32 v15, v23
    s_branch sequential_preLN__ssm_conv_s4d__geglu_ffn__prompt_kernel_cq_3
sequential_preLN__ssm_conv_s4d__geglu_ffn__prompt_kernel_cq_2:
    v_mov_b32 v8, v24
    v_mov_b32 v9, v25
    v_mov_b32 v10, v26
    v_mov_b32 v11, v27
    v_mov_b32 v12, v28
    v_mov_b32 v13, v29
    v_mov_b32 v14, v30
    v_mov_b32 v15, v31
sequential_preLN__ssm_conv_s4d__geglu_ffn__prompt_kernel_cq_3:
    ds_write_b128 v4, v[8:11] offset:8704
    ds_write_b128 v4, v[12:15] offset:8832
    v_add_f32 v44, v44, v45
    v_add_f32 v46, v46, v47
    s_nop 0
    v_add_f32_dpp v44, v44, v44 quad_perm:[1,0,3,2] row_mask:0xf bank_mask:0xf
    v_add_f32_dpp v46, v46, v46 quad_perm:[1,0,3,2] row_mask:0xf bank_mask:0xf
    s_nop 0
    v_add_f32_dpp v44, v44, v44 quad_perm:[2,3,0,1] row_mask:0xf bank_mask:0xf
    v_add_f32_dpp v46, v46, v46 quad_perm:[2,3,0,1] row_mask:0xf bank_mask:0xf
    s_nop 0
    v_add_f32_dpp v44, v44, v44 row_half_mirror row_mask:0xf bank_mask:0xf
    v_add_f32_dpp v46, v46, v46 row_half_mirror row_mask:0xf bank_mask:0xf
    s_mov_b32 s33, 0x3b000000
    s_mov_b32 s34, 0xffff0000
    s_mov_b32 s35, 0x3727c5ac
    v_mul_f32 v44, s33, v44
    v_mul_f32 v46, s33, v46
    v_fma_f32 v46, -v44, v44, v46
    v_max_f32 v46, 0, v46
    v_cvt_pk_bf16_f32 v45, v44, v46
    v_lshlrev_b32 v44, 16, v45
    v_and_b32 v46, s34, v45
    v_add_f32 v46, s35, v46
    v_cvt_pk_bf16_f32 v46, v46, v46
    v_and_b32 v46, s34, v46
    v_sqrt_f32 v46, v46
    s_nop 0
    v_cvt_pk_bf16_f32 v46, v46, v46
    v_and_b32 v46, s34, v46
    v_rcp_f32 v46, v46
    v_mov_b32 v45, v44
    v_mov_b32 v47, v46
    v_lshlrev_b32 v24, 16, v8
    v_lshlrev_b32 v26, 16, v9
    v_lshlrev_b32 v28, 16, v10
    v_lshlrev_b32 v30, 16, v11
    v_and_b32 v25, s34, v8
    v_and_b32 v27, s34, v9
    v_and_b32 v29, s34, v10
    v_and_b32 v31, s34, v11
    v_pk_add_f32 v[24:25], v[24:25], v[44:45] neg_lo:[0,1] neg_hi:[0,1]
    v_pk_add_f32 v[26:27], v[26:27], v[44:45] neg_lo:[0,1] neg_hi:[0,1]
    v_pk_add_f32 v[28:29], v[28:29], v[44:45] neg_lo:[0,1] neg_hi:[0,1]
    v_pk_add_f32 v[30:31], v[30:31], v[44:45] neg_lo:[0,1] neg_hi:[0,1]
    v_pk_mul_f32 v[24:25], v[24:25], v[46:47]
    v_pk_mul_f32 v[26:27], v[26:27], v[46:47]
    v_pk_mul_f32 v[28:29], v[28:29], v[46:47]
    v_pk_mul_f32 v[30:31], v[30:31], v[46:47]
    v_cvt_pk_f16_f32 v48, v24, v25
    v_cvt_pk_f16_f32 v49, v26, v27
    v_cvt_pk_f16_f32 v50, v28, v29
    v_cvt_pk_f16_f32 v51, v30, v31
    v_lshlrev_b32 v32, 16, v12
    v_lshlrev_b32 v34, 16, v13
    v_lshlrev_b32 v36, 16, v14
    v_lshlrev_b32 v38, 16, v15
    v_and_b32 v33, s34, v12
    v_and_b32 v35, s34, v13
    v_and_b32 v37, s34, v14
    v_and_b32 v39, s34, v15
    v_pk_add_f32 v[32:33], v[32:33], v[44:45] neg_lo:[0,1] neg_hi:[0,1]
    v_pk_add_f32 v[34:35], v[34:35], v[44:45] neg_lo:[0,1] neg_hi:[0,1]
    v_pk_add_f32 v[36:37], v[36:37], v[44:45] neg_lo:[0,1] neg_hi:[0,1]
    v_pk_add_f32 v[38:39], v[38:39], v[44:45] neg_lo:[0,1] neg_hi:[0,1]
    v_pk_mul_f32 v[32:33], v[32:33], v[46:47]
    v_pk_mul_f32 v[34:35], v[34:35], v[46:47]
    v_pk_mul_f32 v[36:37], v[36:37], v[46:47]
    v_pk_mul_f32 v[38:39], v[38:39], v[46:47]
    v_cvt_pk_f16_f32 v52, v32, v33
    v_cvt_pk_f16_f32 v53, v34, v35
    v_cvt_pk_f16_f32 v54, v36, v37
    v_cvt_pk_f16_f32 v55, v38, v39
    ds_write_b128 v4, v[48:51]
    ds_write_b128 v4, v[52:55] offset:128
    s_waitcnt lgkmcnt(0)
    s_barrier
    ds_read_b64_tr_b16 v[8:9], v40 offset:8704
    ds_read_b64_tr_b16 v[10:11], v40 offset:9792
    ds_read_b64_tr_b16 v[12:13], v40 offset:8736
    ds_read_b64_tr_b16 v[14:15], v40 offset:9824
    ds_read_b64_tr_b16 v[16:17], v40 offset:0
    ds_read_b64_tr_b16 v[18:19], v40 offset:1088
    ds_read_b64_tr_b16 v[20:21], v40 offset:32
    ds_read_b64_tr_b16 v[22:23], v40 offset:1120
    s_waitcnt lgkmcnt(6)
    buffer_store_dwordx4 v[8:11], v41, s[12:15], s22 offen sc1
    s_waitcnt lgkmcnt(4)
    buffer_store_dwordx4 v[12:15], v41, s[12:15], s23 offen sc1
    s_waitcnt lgkmcnt(2)
    buffer_store_dwordx4 v[16:19], v41, s[8:11], s22 offen sc1
    s_waitcnt lgkmcnt(0)
    buffer_store_dwordx4 v[20:23], v41, s[8:11], s23 offen sc1
    v_and_b32 v1, 63, v0
    v_mov_b32 v124, v0
    s_lshr_b32 s19, s18, 1
    s_and_b32 s20, s18, 1
    s_lshl_b32 s21, s2, 1
    s_add_u32 s21, s21, s19
    s_mov_b32 s23, s99
    v_mov_b32 v8, v144
    v_mov_b32 v9, v145
    v_mov_b32 v10, v146
    v_mov_b32 v11, v147
    v_mov_b32 v12, v148
    v_mov_b32 v13, v149
    v_mov_b32 v14, v150
    v_mov_b32 v15, v151
    s_waitcnt lgkmcnt(0)
    s_lshl_b32 s59, s19, 4
    s_lshr_b32 s23, s23, s59
    s_lshl_b32 s23, s23, 16
    s_mov_b32 s64, 0x3fb8aa3b
    s_mov_b32 s65, 0x3e22f983
    v_mov_b32 v38, s23
    v_mul_f32 v38, s64, v38
    v_exp_f32 v38, v38
    s_nop 0
    v_cvt_pk_bf16_f32 v38, v38, v38
    v_lshlrev_b32 v38, 16, v38
    s_waitcnt vmcnt(5)
    v_lshlrev_b32 v128, 16, v128
    v_mul_f32 v128, s64, v128
    v_exp_f32 v128, v128
    v_lshlrev_b32 v129, 16, v129
    v_lshlrev_b32 v130, 16, v130
    v_lshlrev_b32 v131, 16, v131
    v_lshlrev_b32 v132, 16, v132
    v_lshlrev_b32 v133, 16, v133
    v_cvt_pk_bf16_f32 v128, v128, v128
    v_lshlrev_b32 v128, 16, v128
    v_mul_f32 v39, v128, v38
    v_mul_f32 v40, v129, v38
    v_mul_f32 v39, s64, v39
    v_mul_f32 v40, s65, v40
    v_max3_f32 v2, |v130|, |v131|, |v132|
    v_max_f32 v2, v2, |v133|
    s_nop 1
    v_max_f32_dpp v2, v2, v2 quad_perm:[1,0,3,2] row_mask:0xf bank_mask:0xf
    s_nop 1
    v_max_f32_dpp v2, v2, v2 quad_perm:[2,3,0,1] row_mask:0xf bank_mask:0xf
    s_nop 1
    v_max_f32_dpp v2, v2, v2 row_half_mirror row_mask:0xf bank_mask:0xf
    s_nop 1
    v_max_f32_dpp v2, v2, v2 row_mirror row_mask:0xf bank_mask:0xf
    s_nop 0
    v_readlane_b32 s4, v2, 0
    v_readlane_b32 s5, v2, 16
    v_readlane_b32 s6, v2, 32
    v_readlane_b32 s7, v2, 48
    s_nop 1
    s_max_u32 s4, s4, s5
    s_nop 0
    s_max_u32 s6, s6, s7
    s_max_u32 s4, s4, s6
    v_frexp_exp_i32_f32 v2, s4
    v_sub_u32 v3, 0, v2
    v_ldexp_f32 v50, v130, v3
    v_ldexp_f32 v51, v131, v3
    v_add_f32 v41, v38, v38
    v_ldexp_f32 v41, v41, v2
    v_mul_f32 v80, 0xc1000000, v39
    v_sub_f32 v82, 0, v39
    v_mul_f32 v84, 0xc3800000, v39
    v_mul_f32 v86, 0xc4800000, v39
    v_mul_f32 v81, 0x41000000, v40
    v_fract_f32 v83, v40
    v_mul_f32 v85, 0x43800000, v40
    v_mul_f32 v87, 0x44800000, v40
    v_fract_f32 v81, v81
    v_exp_f32 v82, v82
    v_fract_f32 v85, v85
    v_fract_f32 v87, v87
    v_exp_f32 v80, v80
    v_cos_f32 v42, v83
    v_exp_f32 v84, v84
    v_exp_f32 v86, v86
    v_cos_f32 v44, v81
    v_sin_f32 v43, v83
    v_cos_f32 v46, v85
    v_cos_f32 v48, v87
    v_sin_f32 v45, v81
    v_mul_f32 v42, v42, v82
    v_sin_f32 v47, v85
    v_sin_f32 v49, v87
    v_mul_f32 v44, v44, v80
    v_mul_f32 v43, v43, v82
    v_mul_f32 v46, v46, v84
    v_mul_f32 v48, v48, v86
    v_mul_f32 v45, v45, v80
    v_mul_f32 v47, v47, v84
    v_mul_f32 v49, v49, v86
    v_mov_b32 v88, 1.0
    v_pk_mul_f32 v[52:53], v[50:51], v[42:43] op_sel:[0,0] op_sel_hi:[0,1]
    v_pk_mul_f32 v[68:69], v[46:47], v[46:47] op_sel:[0,0] op_sel_hi:[0,1]
    v_mov_b32 v89, 0
    v_pk_fma_f32 v[52:53], v[50:51], v[42:43], v[52:53] op_sel:[1,1,0] op_sel_hi:[1,0,1] neg_lo:[0,1,0]
    v_pk_fma_f32 v[68:69], v[46:47], v[46:47], v[68:69] op_sel:[1,1,0] op_sel_hi:[1,0,1] neg_lo:[0,1,0]
    v_mov_b32 v90, v44
    v_pk_mul_f32 v[54:55], v[52:53], v[42:43] op_sel:[0,0] op_sel_hi:[0,1]
    v_pk_mul_f32 v[72:73], v[48:49], v[46:47] op_sel:[0,0] op_sel_hi:[0,1]
    v_mov_b32 v91, v45
    v_pk_fma_f32 v[54:55], v[52:53], v[42:43], v[54:55] op_sel:[1,1,0] op_sel_hi:[1,0,1] neg_lo:[0,1,0]
    v_pk_fma_f32 v[72:73], v[48:49], v[46:47], v[72:73] op_sel:[1,1,0] op_sel_hi:[1,0,1] neg_lo:[0,1,0]
    v_pk_mul_f32 v[92:93], v[44:45], v[44:45] op_sel:[0,0] op_sel_hi:[0,1]
    v_pk_mul_f32 v[56:57], v[54:55], v[42:43] op_sel:[0,0] op_sel_hi:[0,1]
    v_pk_mul_f32 v[70:71], v[68:69], v[46:47] op_sel:[0,0] op_sel_hi:[0,1]
    v_pk_fma_f32 v[92:93], v[44:45], v[44:45], v[92:93] op_sel:[1,1,0] op_sel_hi:[1,0,1] neg_lo:[0,1,0]
    v_pk_fma_f32 v[56:57], v[54:55], v[42:43], v[56:57] op_sel:[1,1,0] op_sel_hi:[1,0,1] neg_lo:[0,1,0]
    v_pk_fma_f32 v[70:71], v[68:69], v[46:47], v[70:71] op_sel:[1,1,0] op_sel_hi:[1,0,1] neg_lo:[0,1,0]
    v_pk_mul_f32 v[94:95], v[92:93], v[44:45] op_sel:[0,0] op_sel_hi:[0,1]
    v_pk_mul_f32 v[58:59], v[56:57], v[42:43] op_sel:[0,0] op_sel_hi:[0,1]
    v_pk_mul_f32 v[74:75], v[48:49], v[68:69] op_sel:[0,0] op_sel_hi:[0,1]
    v_pk_fma_f32 v[94:95], v[92:93], v[44:45], v[94:95] op_sel:[1,1,0] op_sel_hi:[1,0,1] neg_lo:[0,1,0]
    v_pk_fma_f32 v[58:59], v[56:57], v[42:43], v[58:59] op_sel:[1,1,0] op_sel_hi:[1,0,1] neg_lo:[0,1,0]
    v_pk_fma_f32 v[74:75], v[48:49], v[68:69], v[74:75] op_sel:[1,1,0] op_sel_hi:[1,0,1] neg_lo:[0,1,0]
    v_pk_mul_f32 v[104:105], v[92:93], v[92:93] op_sel:[0,0] op_sel_hi:[0,1]
    v_pk_mul_f32 v[60:61], v[58:59], v[42:43] op_sel:[0,0] op_sel_hi:[0,1]
    v_pk_mul_f32 v[76:77], v[48:49], v[70:71] op_sel:[0,0] op_sel_hi:[0,1]
    v_pk_fma_f32 v[104:105], v[92:93], v[92:93], v[104:105] op_sel:[1,1,0] op_sel_hi:[1,0,1] neg_lo:[0,1,0]
    v_pk_fma_f32 v[60:61], v[58:59], v[42:43], v[60:61] op_sel:[1,1,0] op_sel_hi:[1,0,1] neg_lo:[0,1,0]
    v_pk_fma_f32 v[76:77], v[48:49], v[70:71], v[76:77] op_sel:[1,1,0] op_sel_hi:[1,0,1] neg_lo:[0,1,0]
    v_pk_mul_f32 v[62:63], v[60:61], v[42:43] op_sel:[0,0] op_sel_hi:[0,1]
    v_pk_fma_f32 v[62:63], v[60:61], v[42:43], v[62:63] op_sel:[1,1,0] op_sel_hi:[1,0,1] neg_lo:[0,1,0]
    v_pk_mul_f32 v[64:65], v[62:63], v[42:43] op_sel:[0,0] op_sel_hi:[0,1]
    v_pk_fma_f32 v[64:65], v[62:63], v[42:43], v[64:65] op_sel:[1,1,0] op_sel_hi:[1,0,1] neg_lo:[0,1,0]
    v_pk_mul_f32 v[66:67], v[64:65], v[42:43] op_sel:[0,0] op_sel_hi:[0,1]
    v_pk_fma_f32 v[66:67], v[64:65], v[42:43], v[66:67] op_sel:[1,1,0] op_sel_hi:[1,0,1] neg_lo:[0,1,0]
    v_pk_mul_f32 v[96:97], v[88:89], v[104:105] op_sel:[0,0] op_sel_hi:[0,1]
    v_pk_mul_f32 v[98:99], v[90:91], v[104:105] op_sel:[0,0] op_sel_hi:[0,1]
    v_pk_mul_f32 v[100:101], v[92:93], v[104:105] op_sel:[0,0] op_sel_hi:[0,1]
    v_pk_mul_f32 v[102:103], v[94:95], v[104:105] op_sel:[0,0] op_sel_hi:[0,1]
    v_pk_fma_f32 v[96:97], v[88:89], v[104:105], v[96:97] op_sel:[1,1,0] op_sel_hi:[1,0,1] neg_lo:[0,1,0]
    v_pk_fma_f32 v[98:99], v[90:91], v[104:105], v[98:99] op_sel:[1,1,0] op_sel_hi:[1,0,1] neg_lo:[0,1,0]
    v_pk_fma_f32 v[100:101], v[92:93], v[104:105], v[100:101] op_sel:[1,1,0] op_sel_hi:[1,0,1] neg_lo:[0,1,0]
    v_pk_fma_f32 v[102:103], v[94:95], v[104:105], v[102:103] op_sel:[1,1,0] op_sel_hi:[1,0,1] neg_lo:[0,1,0]
    v_cvt_pk_f16_f32 v108, v88, v90
    v_cvt_pk_f16_f32 v109, v92, v94
    v_cvt_pk_f16_f32 v110, v96, v98
    v_cvt_pk_f16_f32 v111, v100, v102
    v_cvt_pk_f16_f32 v112, v89, v91
    v_cvt_pk_f16_f32 v113, v93, v95
    v_cvt_pk_f16_f32 v114, v97, v99
    v_cvt_pk_f16_f32 v115, v101, v103
    ds_write_b128 v8, v[108:111] offset:0
    ds_write_b128 v8, v[112:115] offset:8192
    v_pk_mul_f32 v[88:89], v[96:97], v[104:105] op_sel:[0,0] op_sel_hi:[0,1]
    v_pk_mul_f32 v[90:91], v[98:99], v[104:105] op_sel:[0,0] op_sel_hi:[0,1]
    v_pk_mul_f32 v[92:93], v[100:101], v[104:105] op_sel:[0,0] op_sel_hi:[0,1]
    v_pk_mul_f32 v[94:95], v[102:103], v[104:105] op_sel:[0,0] op_sel_hi:[0,1]
    v_pk_fma_f32 v[88:89], v[96:97], v[104:105], v[88:89] op_sel:[1,1,0] op_sel_hi:[1,0,1] neg_lo:[0,1,0]
    v_pk_fma_f32 v[90:91], v[98:99], v[104:105], v[90:91] op_sel:[1,1,0] op_sel_hi:[1,0,1] neg_lo:[0,1,0]
    v_pk_fma_f32 v[92:93], v[100:101], v[104:105], v[92:93] op_sel:[1,1,0] op_sel_hi:[1,0,1] neg_lo:[0,1,0]
    v_pk_fma_f32 v[94:95], v[102:103], v[104:105], v[94:95] op_sel:[1,1,0] op_sel_hi:[1,0,1] neg_lo:[0,1,0]
    v_pk_mul_f32 v[96:97], v[88:89], v[104:105] op_sel:[0,0] op_sel_hi:[0,1]
    v_pk_mul_f32 v[98:99], v[90:91], v[104:105] op_sel:[0,0] op_sel_hi:[0,1]
    v_pk_mul_f32 v[100:101], v[92:93], v[104:105] op_sel:[0,0] op_sel_hi:[0,1]
    v_pk_mul_f32 v[102:103], v[94:95], v[104:105] op_sel:[0,0] op_sel_hi:[0,1]
    v_pk_fma_f32 v[96:97], v[88:89], v[104:105], v[96:97] op_sel:[1,1,0] op_sel_hi:[1,0,1] neg_lo:[0,1,0]
    v_pk_fma_f32 v[98:99], v[90:91], v[104:105], v[98:99] op_sel:[1,1,0] op_sel_hi:[1,0,1] neg_lo:[0,1,0]
    v_pk_fma_f32 v[100:101], v[92:93], v[104:105], v[100:101] op_sel:[1,1,0] op_sel_hi:[1,0,1] neg_lo:[0,1,0]
    v_pk_fma_f32 v[102:103], v[94:95], v[104:105], v[102:103] op_sel:[1,1,0] op_sel_hi:[1,0,1] neg_lo:[0,1,0]
    v_cvt_pk_f16_f32 v116, v88, v90
    v_cvt_pk_f16_f32 v117, v92, v94
    v_cvt_pk_f16_f32 v118, v96, v98
    v_cvt_pk_f16_f32 v119, v100, v102
    v_cvt_pk_f16_f32 v120, v89, v91
    v_cvt_pk_f16_f32 v121, v93, v95
    v_cvt_pk_f16_f32 v122, v97, v99
    v_cvt_pk_f16_f32 v123, v101, v103
    ds_write_b128 v9, v[116:119] offset:0
    ds_write_b128 v9, v[120:123] offset:8192
    v_pk_mul_f32 v[88:89], v[96:97], v[104:105] op_sel:[0,0] op_sel_hi:[0,1]
    v_pk_mul_f32 v[90:91], v[98:99], v[104:105] op_sel:[0,0] op_sel_hi:[0,1]
    v_pk_mul_f32 v[92:93], v[100:101], v[104:105] op_sel:[0,0] op_sel_hi:[0,1]
    v_pk_mul_f32 v[94:95], v[102:103], v[104:105] op_sel:[0,0] op_sel_hi:[0,1]
    v_pk_fma_f32 v[88:89], v[96:97], v[104:105], v[88:89] op_sel:[1,1,0] op_sel_hi:[1,0,1] neg_lo:[0,1,0]
    v_pk_fma_f32 v[90:91], v[98:99], v[104:105], v[90:91] op_sel:[1,1,0] op_sel_hi:[1,0,1] neg_lo:[0,1,0]
    v_pk_fma_f32 v[92:93], v[100:101], v[104:105], v[92:93] op_sel:[1,1,0] op_sel_hi:[1,0,1] neg_lo:[0,1,0]
    v_pk_fma_f32 v[94:95], v[102:103], v[104:105], v[94:95] op_sel:[1,1,0] op_sel_hi:[1,0,1] neg_lo:[0,1,0]
    v_pk_mul_f32 v[96:97], v[88:89], v[104:105] op_sel:[0,0] op_sel_hi:[0,1]
    v_pk_mul_f32 v[98:99], v[90:91], v[104:105] op_sel:[0,0] op_sel_hi:[0,1]
    v_pk_mul_f32 v[100:101], v[92:93], v[104:105] op_sel:[0,0] op_sel_hi:[0,1]
    v_pk_mul_f32 v[102:103], v[94:95], v[104:105] op_sel:[0,0] op_sel_hi:[0,1]
    v_pk_fma_f32 v[96:97], v[88:89], v[104:105], v[96:97] op_sel:[1,1,0] op_sel_hi:[1,0,1] neg_lo:[0,1,0]
    v_pk_fma_f32 v[98:99], v[90:91], v[104:105], v[98:99] op_sel:[1,1,0] op_sel_hi:[1,0,1] neg_lo:[0,1,0]
    v_pk_fma_f32 v[100:101], v[92:93], v[104:105], v[100:101] op_sel:[1,1,0] op_sel_hi:[1,0,1] neg_lo:[0,1,0]
    v_pk_fma_f32 v[102:103], v[94:95], v[104:105], v[102:103] op_sel:[1,1,0] op_sel_hi:[1,0,1] neg_lo:[0,1,0]
    v_cvt_pk_f16_f32 v108, v88, v90
    v_cvt_pk_f16_f32 v109, v92, v94
    v_cvt_pk_f16_f32 v110, v96, v98
    v_cvt_pk_f16_f32 v111, v100, v102
    v_cvt_pk_f16_f32 v112, v89, v91
    v_cvt_pk_f16_f32 v113, v93, v95
    v_cvt_pk_f16_f32 v114, v97, v99
    v_cvt_pk_f16_f32 v115, v101, v103
    ds_write_b128 v10, v[108:111] offset:0
    ds_write_b128 v10, v[112:115] offset:8192
    v_pk_mul_f32 v[88:89], v[96:97], v[104:105] op_sel:[0,0] op_sel_hi:[0,1]
    v_pk_mul_f32 v[90:91], v[98:99], v[104:105] op_sel:[0,0] op_sel_hi:[0,1]
    v_pk_mul_f32 v[92:93], v[100:101], v[104:105] op_sel:[0,0] op_sel_hi:[0,1]
    v_pk_mul_f32 v[94:95], v[102:103], v[104:105] op_sel:[0,0] op_sel_hi:[0,1]
    v_pk_fma_f32 v[88:89], v[96:97], v[104:105], v[88:89] op_sel:[1,1,0] op_sel_hi:[1,0,1] neg_lo:[0,1,0]
    v_pk_fma_f32 v[90:91], v[98:99], v[104:105], v[90:91] op_sel:[1,1,0] op_sel_hi:[1,0,1] neg_lo:[0,1,0]
    v_pk_fma_f32 v[92:93], v[100:101], v[104:105], v[92:93] op_sel:[1,1,0] op_sel_hi:[1,0,1] neg_lo:[0,1,0]
    v_pk_fma_f32 v[94:95], v[102:103], v[104:105], v[94:95] op_sel:[1,1,0] op_sel_hi:[1,0,1] neg_lo:[0,1,0]
    v_pk_mul_f32 v[96:97], v[88:89], v[104:105] op_sel:[0,0] op_sel_hi:[0,1]
    v_pk_mul_f32 v[98:99], v[90:91], v[104:105] op_sel:[0,0] op_sel_hi:[0,1]
    v_pk_mul_f32 v[100:101], v[92:93], v[104:105] op_sel:[0,0] op_sel_hi:[0,1]
    v_pk_mul_f32 v[102:103], v[94:95], v[104:105] op_sel:[0,0] op_sel_hi:[0,1]
    v_pk_fma_f32 v[96:97], v[88:89], v[104:105], v[96:97] op_sel:[1,1,0] op_sel_hi:[1,0,1] neg_lo:[0,1,0]
    v_pk_fma_f32 v[98:99], v[90:91], v[104:105], v[98:99] op_sel:[1,1,0] op_sel_hi:[1,0,1] neg_lo:[0,1,0]
    v_pk_fma_f32 v[100:101], v[92:93], v[104:105], v[100:101] op_sel:[1,1,0] op_sel_hi:[1,0,1] neg_lo:[0,1,0]
    v_pk_fma_f32 v[102:103], v[94:95], v[104:105], v[102:103] op_sel:[1,1,0] op_sel_hi:[1,0,1] neg_lo:[0,1,0]
    v_cvt_pk_f16_f32 v116, v88, v90
    v_cvt_pk_f16_f32 v117, v92, v94
    v_cvt_pk_f16_f32 v118, v96, v98
    v_cvt_pk_f16_f32 v119, v100, v102
    v_cvt_pk_f16_f32 v120, v89, v91
    v_cvt_pk_f16_f32 v121, v93, v95
    v_cvt_pk_f16_f32 v122, v97, v99
    v_cvt_pk_f16_f32 v123, v101, v103
    ds_write_b128 v11, v[116:119] offset:0
    ds_write_b128 v11, v[120:123] offset:8192
    s_waitcnt vmcnt(0)
    s_barrier
    s_add_u32 s98, s98, 1
    s_cmp_lg_u32 s18, 0
    s_cbranch_scc1 sequential_preLN__ssm_conv_s4d__geglu_ffn__prompt_kernel_nosig_4
    s_add_u32 s56, s16, 0xfa0000
    s_addc_u32 s57, s17, 0
    s_mov_b32 s58, 0x10400
    s_mov_b32 s59, 0x20000
    v_mov_b32 v2, s98
    v_lshlrev_b32 v3, 8, v1
    s_lshl_b32 s33, s67, 14
    s_lshl_b32 s34, s66, 2
    s_add_u32 s33, s33, s34
    buffer_store_dword v2, v3, s[56:59], s33 offen sc1
sequential_preLN__ssm_conv_s4d__geglu_ffn__prompt_kernel_nosig_4:
    v_cvt_pk_f16_f32 v108, v50, v52
    v_cvt_pk_f16_f32 v109, v54, v56
    v_cvt_pk_f16_f32 v110, v58, v60
    v_cvt_pk_f16_f32 v111, v62, v64
    v_cvt_pk_f16_f32 v112, -v51, -v53
    v_cvt_pk_f16_f32 v113, -v55, -v57
    v_cvt_pk_f16_f32 v114, -v59, -v61
    v_cvt_pk_f16_f32 v115, -v63, -v65
    ds_write_b128 v8, v[108:111] offset:16384
    ds_write_b128 v8, v[112:115] offset:24576
    v_pk_mul_f32 v[80:81], v[50:51], v[46:47] op_sel:[0,0] op_sel_hi:[0,1]
    v_pk_mul_f32 v[82:83], v[54:55], v[46:47] op_sel:[0,0] op_sel_hi:[0,1]
    v_pk_mul_f32 v[84:85], v[58:59], v[46:47] op_sel:[0,0] op_sel_hi:[0,1]
    v_pk_mul_f32 v[86:87], v[62:63], v[46:47] op_sel:[0,0] op_sel_hi:[0,1]
    v_pk_mul_f32 v[88:89], v[66:67], v[46:47] op_sel:[0,0] op_sel_hi:[0,1]
    v_pk_fma_f32 v[80:81], v[50:51], v[46:47], v[80:81] op_sel:[1,1,0] op_sel_hi:[1,0,1] neg_lo:[0,1,0]
    v_pk_fma_f32 v[82:83], v[54:55], v[46:47], v[82:83] op_sel:[1,1,0] op_sel_hi:[1,0,1] neg_lo:[0,1,0]
    v_pk_fma_f32 v[84:85], v[58:59], v[46:47], v[84:85] op_sel:[1,1,0] op_sel_hi:[1,0,1] neg_lo:[0,1,0]
    v_pk_fma_f32 v[86:87], v[62:63], v[46:47], v[86:87] op_sel:[1,1,0] op_sel_hi:[1,0,1] neg_lo:[0,1,0]
    v_pk_fma_f32 v[88:89], v[66:67], v[46:47], v[88:89] op_sel:[1,1,0] op_sel_hi:[1,0,1] neg_lo:[0,1,0]
    v_cvt_pk_f16_f32 v116, v80, v82
    v_cvt_pk_f16_f32 v117, v84, v84
    v_cvt_pk_f16_f32 v118, v84, v86
    v_cvt_pk_f16_f32 v119, v88, v88
    v_cvt_pk_f16_f32 v120, -v81, -v83
    v_cvt_pk_f16_f32 v121, -v85, -v85
    v_cvt_pk_f16_f32 v122, -v85, -v87
    v_cvt_pk_f16_f32 v123, -v89, -v89
    ds_write_b128 v9, v[116:119] offset:16384
    ds_write_b128 v9, v[120:123] offset:24576
    v_pk_mul_f32 v[96:97], v[50:51], v[68:69] op_sel:[0,0] op_sel_hi:[0,1]
    v_pk_mul_f32 v[98:99], v[58:59], v[68:69] op_sel:[0,0] op_sel_hi:[0,1]
    v_pk_mul_f32 v[100:101], v[66:67], v[68:69] op_sel:[0,0] op_sel_hi:[0,1]
    v_pk_mul_f32 v[102:103], v[50:51], v[70:71] op_sel:[0,0] op_sel_hi:[0,1]
    v_pk_mul_f32 v[104:105], v[58:59], v[70:71] op_sel:[0,0] op_sel_hi:[0,1]
    v_pk_mul_f32 v[106:107], v[66:67], v[70:71] op_sel:[0,0] op_sel_hi:[0,1]
    v_pk_fma_f32 v[96:97], v[50:51], v[68:69], v[96:97] op_sel:[1,1,0] op_sel_hi:[1,0,1] neg_lo:[0,1,0]
    v_pk_fma_f32 v[98:99], v[58:59], v[68:69], v[98:99] op_sel:[1,1,0] op_sel_hi:[1,0,1] neg_lo:[0,1,0]
    v_pk_fma_f32 v[100:101], v[66:67], v[68:69], v[100:101] op_sel:[1,1,0] op_sel_hi:[1,0,1] neg_lo:[0,1,0]
    v_pk_fma_f32 v[102:103], v[50:51], v[70:71], v[102:103] op_sel:[1,1,0] op_sel_hi:[1,0,1] neg_lo:[0,1,0]
    v_pk_fma_f32 v[104:105], v[58:59], v[70:71], v[104:105] op_sel:[1,1,0] op_sel_hi:[1,0,1] neg_lo:[0,1,0]
    v_pk_fma_f32 v[106:107], v[66:67], v[70:71], v[106:107] op_sel:[1,1,0] op_sel_hi:[1,0,1] neg_lo:[0,1,0]
    v_cvt_pk_f16_f32 v108, v96, v98
    v_cvt_pk_f16_f32 v109, v100, v100
    v_cvt_pk_f16_f32 v110, v102, v104
    v_cvt_pk_f16_f32 v111, v106, v106
    v_cvt_pk_f16_f32 v112, -v97, -v99
    v_cvt_pk_f16_f32 v113, -v101, -v101
    v_cvt_pk_f16_f32 v114, -v103, -v105
    v_cvt_pk_f16_f32 v115, -v107, -v107
    ds_write_b128 v10, v[108:111] offset:16384
    ds_write_b128 v10, v[112:115] offset:24576
    v_pk_mul_f32 v[80:81], v[50:51], v[48:49] op_sel:[0,0] op_sel_hi:[0,1]
    v_pk_mul_f32 v[82:83], v[66:67], v[48:49] op_sel:[0,0] op_sel_hi:[0,1]
    v_pk_mul_f32 v[84:85], v[50:51], v[72:73] op_sel:[0,0] op_sel_hi:[0,1]
    v_pk_mul_f32 v[86:87], v[66:67], v[72:73] op_sel:[0,0] op_sel_hi:[0,1]
    v_pk_mul_f32 v[88:89], v[50:51], v[74:75] op_sel:[0,0] op_sel_hi:[0,1]
    v_pk_mul_f32 v[90:91], v[66:67], v[74:75] op_sel:[0,0] op_sel_hi:[0,1]
    v_pk_mul_f32 v[92:93], v[50:51], v[76:77] op_sel:[0,0] op_sel_hi:[0,1]
    v_pk_mul_f32 v[94:95], v[66:67], v[76:77] op_sel:[0,0] op_sel_hi:[0,1]
    v_pk_fma_f32 v[80:81], v[50:51], v[48:49], v[80:81] op_sel:[1,1,0] op_sel_hi:[1,0,1] neg_lo:[0,1,0]
    v_pk_fma_f32 v[82:83], v[66:67], v[48:49], v[82:83] op_sel:[1,1,0] op_sel_hi:[1,0,1] neg_lo:[0,1,0]
    v_pk_fma_f32 v[84:85], v[50:51], v[72:73], v[84:85] op_sel:[1,1,0] op_sel_hi:[1,0,1] neg_lo:[0,1,0]
    v_pk_fma_f32 v[86:87], v[66:67], v[72:73], v[86:87] op_sel:[1,1,0] op_sel_hi:[1,0,1] neg_lo:[0,1,0]
    v_pk_fma_f32 v[88:89], v[50:51], v[74:75], v[88:89] op_sel:[1,1,0] op_sel_hi:[1,0,1] neg_lo:[0,1,0]
    v_pk_fma_f32 v[90:91], v[66:67], v[74:75], v[90:91] op_sel:[1,1,0] op_sel_hi:[1,0,1] neg_lo:[0,1,0]
    v_pk_fma_f32 v[92:93], v[50:51], v[76:77], v[92:93] op_sel:[1,1,0] op_sel_hi:[1,0,1] neg_lo:[0,1,0]
    v_pk_fma_f32 v[94:95], v[66:67], v[76:77], v[94:95] op_sel:[1,1,0] op_sel_hi:[1,0,1] neg_lo:[0,1,0]
    s_waitcnt lgkmcnt(8)
    v_cvt_pk_f16_f32 v116, v80, v82
    v_cvt_pk_f16_f32 v117, v84, v86
    v_cvt_pk_f16_f32 v118, v88, v90
    v_cvt_pk_f16_f32 v119, v92, v94
    v_cvt_pk_f16_f32 v120, -v81, -v83
    v_cvt_pk_f16_f32 v121, -v85, -v87
    v_cvt_pk_f16_f32 v122, -v89, -v91
    v_cvt_pk_f16_f32 v123, -v93, -v95
    ds_write_b128 v11, v[116:119] offset:16384
    ds_write_b128 v11, v[120:123] offset:24576
    s_waitcnt lgkmcnt(0)
    s_barrier
    ds_read_b64_tr_b16 v[80:81], v12 offset:16384
    ds_read_b64_tr_b16 v[82:83], v13 offset:16640
    ds_read_b64_tr_b16 v[84:85], v14 offset:0
    ds_read_b64_tr_b16 v[86:87], v15 offset:256
    ds_read_b64_tr_b16 v[88:89], v12 offset:17408
    ds_read_b64_tr_b16 v[90:91], v13 offset:17664
    ds_read_b64_tr_b16 v[92:93], v14 offset:1024
    ds_read_b64_tr_b16 v[94:95], v15 offset:1280
    ds_read_b64_tr_b16 v[96:97], v12 offset:18432
    ds_read_b64_tr_b16 v[98:99], v13 offset:18688
    ds_read_b64_tr_b16 v[100:101], v14 offset:2048
    ds_read_b64_tr_b16 v[102:103], v15 offset:2304
    s_waitcnt lgkmcnt(8)
    v_mfma_f32_32x32x16_f16 v[64:79], v[80:83], v[84:87], 0
    ds_read_b64_tr_b16 v[80:81], v12 offset:19456
    ds_read_b64_tr_b16 v[82:83], v13 offset:19712
    ds_read_b64_tr_b16 v[84:85], v14 offset:3072
    ds_read_b64_tr_b16 v[86:87], v15 offset:3328
    s_waitcnt lgkmcnt(8)
    v_mfma_f32_32x32x16_f16 v[64:79], v[88:91], v[92:95], v[64:79]
    ds_read_b64_tr_b16 v[88:89], v12 offset:20480
    ds_read_b64_tr_b16 v[90:91], v13 offset:20736
    ds_read_b64_tr_b16 v[92:93], v14 offset:4096
    ds_read_b64_tr_b16 v[94:95], v15 offset:4352
    s_waitcnt lgkmcnt(8)
    v_mfma_f32_32x32x16_f16 v[64:79], v[96:99], v[100:103], v[64:79]
    ds_read_b64_tr_b16 v[96:97], v12 offset:21504
    ds_read_b64_tr_b16 v[98:99], v13 offset:21760
    ds_read_b64_tr_b16 v[100:101], v14 offset:5120
    ds_read_b64_tr_b16 v[102:103], v15 offset:5376
    s_waitcnt lgkmcnt(8)
    v_mfma_f32_32x32x16_f16 v[64:79], v[80:83], v[84:87], v[64:79]
    ds_read_b64_tr_b16 v[80:81], v12 offset:22528
    ds_read_b64_tr_b16 v[82:83], v13 offset:22784
    ds_read_b64_tr_b16 v[84:85], v14 offset:6144
    ds_read_b64_tr_b16 v[86:87], v15 offset:6400
    s_waitcnt lgkmcnt(8)
    v_mfma_f32_32x32x16_f16 v[64:79], v[88:91], v[92:95], v[64:79]
    ds_read_b64_tr_b16 v[88:89], v12 offset:23552
    ds_read_b64_tr_b16 v[90:91], v13 offset:23808
    ds_read_b64_tr_b16 v[92:93], v14 offset:7168
    ds_read_b64_tr_b16 v[94:95], v15 offset:7424
    s_waitcnt lgkmcnt(8)
    v_mfma_f32_32x32x16_f16 v[64:79], v[96:99], v[100:103], v[64:79]
    ds_read_b64_tr_b16 v[96:97], v12 offset:24576
    ds_read_b64_tr_b16 v[98:99], v13 offset:24832
    ds_read_b64_tr_b16 v[100:101], v14 offset:8192
    ds_read_b64_tr_b16 v[102:103], v15 offset:8448
    s_waitcnt lgkmcnt(8)
    v_mfma_f32_32x32x16_f16 v[64:79], v[80:83], v[84:87], v[64:79]
    ds_read_b64_tr_b16 v[80:81], v12 offset:25600
    ds_read_b64_tr_b16 v[82:83], v13 offset:25856
    ds_read_b64_tr_b16 v[84:85], v14 offset:9216
    ds_read_b64_tr_b16 v[86:87], v15 offset:9472
    s_waitcnt lgkmcnt(8)
    v_mfma_f32_32x32x16_f16 v[64:79], v[88:91], v[92:95], v[64:79]
    ds_read_b64_tr_b16 v[88:89], v12 offset:26624
    ds_read_b64_tr_b16 v[90:91], v13 offset:26880
    ds_read_b64_tr_b16 v[92:93], v14 offset:10240
    ds_read_b64_tr_b16 v[94:95], v15 offset:10496
    s_waitcnt lgkmcnt(8)
    v_mfma_f32_32x32x16_f16 v[64:79], v[96:99], v[100:103], v[64:79]
    ds_read_b64_tr_b16 v[96:97], v12 offset:27648
    ds_read_b64_tr_b16 v[98:99], v13 offset:27904
    ds_read_b64_tr_b16 v[100:101], v14 offset:11264
    ds_read_b64_tr_b16 v[102:103], v15 offset:11520
    s_waitcnt lgkmcnt(8)
    v_mfma_f32_32x32x16_f16 v[64:79], v[80:83], v[84:87], v[64:79]
    ds_read_b64_tr_b16 v[80:81], v12 offset:28672
    ds_read_b64_tr_b16 v[82:83], v13 offset:28928
    ds_read_b64_tr_b16 v[84:85], v14 offset:12288
    ds_read_b64_tr_b16 v[86:87], v15 offset:12544
    s_waitcnt lgkmcnt(8)
    v_mfma_f32_32x32x16_f16 v[64:79], v[88:91], v[92:95], v[64:79]
    ds_read_b64_tr_b16 v[88:89], v12 offset:29696
    ds_read_b64_tr_b16 v[90:91], v13 offset:29952
    ds_read_b64_tr_b16 v[92:93], v14 offset:13312
    ds_read_b64_tr_b16 v[94:95], v15 offset:13568
    s_waitcnt lgkmcnt(8)
    v_mfma_f32_32x32x16_f16 v[64:79], v[96:99], v[100:103], v[64:79]
    ds_read_b64_tr_b16 v[96:97], v12 offset:30720
    ds_read_b64_tr_b16 v[98:99], v13 offset:30976
    ds_read_b64_tr_b16 v[100:101], v14 offset:14336
    ds_read_b64_tr_b16 v[102:103], v15 offset:14592
    s_waitcnt lgkmcnt(8)
    v_mfma_f32_32x32x16_f16 v[64:79], v[80:83], v[84:87], v[64:79]
    ds_read_b64_tr_b16 v[80:81], v12 offset:31744
    ds_read_b64_tr_b16 v[82:83], v13 offset:32000
    ds_read_b64_tr_b16 v[84:85], v14 offset:15360
    ds_read_b64_tr_b16 v[86:87], v15 offset:15616
    s_waitcnt lgkmcnt(8)
    v_mfma_f32_32x32x16_f16 v[64:79], v[88:91], v[92:95], v[64:79]
    s_waitcnt lgkmcnt(4)
    v_mfma_f32_32x32x16_f16 v[64:79], v[96:99], v[100:103], v[64:79]
    s_waitcnt lgkmcnt(0)
    v_mfma_f32_32x32x16_f16 v[64:79], v[80:83], v[84:87], v[64:79]
    v_cmp_lt_u32 vcc, 31, v1
    v_and_b32 v2, 33, v1
    v_cmp_eq_u32 s[4:5], 33, v2
    v_and_b32 v18, 31, v1
    v_lshlrev_b32 v18, 4, v18
    v_lshrrev_b32 v2, 5, v1
    v_lshl_add_u32 v18, v2, 3, v18
    s_mul_i32 s57, s19, 16640
    s_add_u32 s57, s57, 82944
    s_lshl_b32 s59, s20, 11
    s_add_u32 s59, s59, s57
    s_add_u32 s59, s59, 64
    v_add_u32 v18, s59, v18
    s_cmp_eq_u32 s20, 1
    s_cbranch_scc1 sequential_preLN__ssm_conv_s4d__geglu_ffn__prompt_kernel_t1_5
    v_cvt_pk_f16_f32 v104, v64, v65
    v_cvt_pk_f16_f32 v105, v66, v67
    v_cvt_pk_f16_f32 v106, v68, v68
    v_cvt_pk_f16_f32 v107, v69, v70
    ds_write_b64 v18, v[104:105]
    ds_write_b64 v18, v[106:107] offset:512
    v_cndmask_b32 v2, v72, v73, vcc
    v_cndmask_b32 v3, v72, v74, vcc
    v_cndmask_b32 v4, v73, v74, vcc
    v_cvt_pk_f16_f32 v108, v2, v2
    v_cvt_pk_f16_f32 v109, v3, v4
    ds_write_b64 v18, v[108:109] offset:1024
    v_cndmask_b32 v2, v76, v77, vcc
    v_cndmask_b32 v3, v76, v78, vcc
    v_cndmask_b32 v4, v77, v78, vcc
    v_cvt_pk_f16_f32 v110, v2, v2
    v_cvt_pk_f16_f32 v111, v3, v4
    ds_write_b64 v18, v[110:111] offset:1536
    s_branch sequential_preLN__ssm_conv_s4d__geglu_ffn__prompt_kernel_kj_6
sequential_preLN__ssm_conv_s4d__geglu_ffn__prompt_kernel_t1_5:
    v_cndmask_b32 v2, v64, v65, vcc
    v_cndmask_b32 v3, v64, v65, s[4:5]
    v_cvt_pk_f16_f32 v105, v2, v2
    v_cvt_pk_f16_f32 v104, v3, v2
    ds_write_b64 v18, v[104:105] offset:0
    v_cndmask_b32 v2, v66, v67, vcc
    v_cndmask_b32 v3, v66, v67, s[4:5]
    v_cvt_pk_f16_f32 v107, v2, v2
    v_cvt_pk_f16_f32 v106, v3, v2
    ds_write_b64 v18, v[106:107] offset:512
    v_cndmask_b32 v2, v68, v69, vcc
    v_cndmask_b32 v3, v68, v69, s[4:5]
    v_cvt_pk_f16_f32 v109, v2, v2
    v_cvt_pk_f16_f32 v108, v3, v2
    ds_write_b64 v18, v[108:109] offset:1024
    v_cndmask_b32 v2, v70, v71, vcc
    v_cndmask_b32 v3, v70, v71, s[4:5]
    v_cvt_pk_f16_f32 v111, v2, v2
    v_cvt_pk_f16_f32 v110, v3, v2
    ds_write_b64 v18, v[110:111] offset:1536
sequential_preLN__ssm_conv_s4d__geglu_ffn__prompt_kernel_kj_6:
    v_mov_b32 v8, 0
    v_mov_b32 v9, 0
    v_mov_b32 v10, 0
    v_mov_b32 v11, 0
    v_bfe_u32 v7, v1, 2, 2
    v_mul_u32_u24 v12, 4160, v7
    v_and_b32 v7, 3, v1
    v_lshl_add_u32 v12, v7, 4, v12
    v_add_u32 v12, s57, v12
    ds_write_b128 v12, v[8:11]
    v_mov_b32 v22, v41
    s_waitcnt lgkmcnt(0)
    s_barrier
    v_lshlrev_b32 v2, 4, v124
    v_add_u32 v2, 83000, v2
    ds_read_b64 v[64:65], v2 offset:0
    ds_read_b128 v[66:69], v2 offset:8
    ds_read_b64 v[80:81], v2 offset:16640
    ds_read_b128 v[82:85], v2 offset:16648
    s_waitcnt lgkmcnt(2)
    v_alignbit_b32 v96, v66, v65, 16
    v_mov_b32 v100, v65
    v_alignbit_b32 v104, v65, v64, 16
    v_alignbit_b32 v97, v67, v66, 16
    v_mov_b32 v101, v66
    v_alignbit_b32 v105, v66, v65, 16
    v_alignbit_b32 v98, v68, v67, 16
    v_mov_b32 v102, v67
    v_alignbit_b32 v106, v67, v66, 16
    v_alignbit_b32 v99, v69, v68, 16
    v_mov_b32 v103, v68
    v_alignbit_b32 v107, v68, v67, 16
    ds_write_b128 v2, v[96:99] offset:4168
    ds_write_b128 v2, v[100:103] offset:8328
    ds_write_b128 v2, v[104:107] offset:12488
    s_waitcnt lgkmcnt(3)
    v_alignbit_b32 v108, v82, v81, 16
    v_mov_b32 v112, v81
    v_alignbit_b32 v116, v81, v80, 16
    v_alignbit_b32 v109, v83, v82, 16
    v_mov_b32 v113, v82
    v_alignbit_b32 v117, v82, v81, 16
    v_alignbit_b32 v110, v84, v83, 16
    v_mov_b32 v114, v83
    v_alignbit_b32 v118, v83, v82, 16
    v_alignbit_b32 v111, v85, v84, 16
    v_mov_b32 v115, v84
    v_alignbit_b32 v119, v84, v83, 16
    ds_write_b128 v2, v[108:111] offset:20808
    ds_write_b128 v2, v[112:115] offset:24968
    ds_write_b128 v2, v[116:119] offset:29128
    s_mov_b32 s24, s97
    s_add_u32 s56, s16, 0xfa0000
    s_addc_u32 s57, s17, 0
    s_mov_b32 s58, 0x10400
    s_mov_b32 s59, 0x20000
    v_mov_b32 v3, v168
    v_mov_b32 v4, v169
    v_mov_b32 v5, v170
    v_mov_b32 v6, v171
    v_mov_b32 v16, v176
    v_mov_b32 v17, v177
    v_mov_b32 v19, v178
    v_mov_b32 v20, v179
    v_mov_b32 v21, v180
    s_waitcnt lgkmcnt(0)
    s_cmp_lg_u32 s18, 0
    s_cbranch_scc1 sequential_preLN__ssm_conv_s4d__geglu_ffn__prompt_kernel_f2w_7
    v_lshlrev_b32 v10, 2, v1
    s_lshl_b32 s33, s2, 8
    s_mov_b32 s36, 1048576
sequential_preLN__ssm_conv_s4d__geglu_ffn__prompt_kernel_f2l_8:
    buffer_load_dword v11, v10, s[56:59], s33 offen sc1
    s_waitcnt vmcnt(0)
    v_cmp_eq_u32 vcc, s98, v11
    s_nop 3
    s_cmp_eq_u64 vcc, exec
    s_cbranch_scc1 sequential_preLN__ssm_conv_s4d__geglu_ffn__prompt_kernel_f2w_7
    s_sub_u32 s36, s36, 1
    s_cmp_lg_u32 s36, 0
    s_cbranch_scc1 sequential_preLN__ssm_conv_s4d__geglu_ffn__prompt_kernel_f2l_8
sequential_preLN__ssm_conv_s4d__geglu_ffn__prompt_kernel_f2w_7:
    s_barrier
    buffer_load_dwordx4 v[32:35], v4, s[44:47], s25 offen sc1
    buffer_load_dwordx4 v[36:39], v4, s[44:47], s25 offen offset:1024 sc1
    buffer_load_dwordx2 v[24:25], v21, s[48:51], s25 offen offset:0 sc1
    buffer_load_dwordx2 v[26:27], v21, s[48:51], s25 offen offset:512 sc1
    buffer_load_dwordx2 v[28:29], v21, s[48:51], s25 offen offset:1024 sc1
    buffer_load_dwordx2 v[30:31], v21, s[48:51], s25 offen offset:1536 sc1
    ds_read_b64_tr_b16 a[0:1], v16 offset:8
    ds_read_b64_tr_b16 a[2:3], v16 offset:0
    ds_read_b64_tr_b16 a[4:5], v16 offset:520
    ds_read_b64_tr_b16 a[6:7], v16 offset:512
    ds_read_b64_tr_b16 a[8:9], v16 offset:1032
    ds_read_b64_tr_b16 a[10:11], v16 offset:1024
    ds_read_b64_tr_b16 a[12:13], v16 offset:1544
    ds_read_b64_tr_b16 a[14:15], v16 offset:1536
    ds_read_b64_tr_b16 a[16:17], v16 offset:2056
    ds_read_b64_tr_b16 a[18:19], v16 offset:2048
    ds_read_b64_tr_b16 a[20:21], v16 offset:2568
    ds_read_b64_tr_b16 a[22:23], v16 offset:2560
    s_waitcnt lgkmcnt(6)
    ds_read_b64_tr_b16 a[24:25], v16 offset:3080
    ds_read_b64_tr_b16 a[26:27], v16 offset:3072
    ds_read_b64_tr_b16 a[28:29], v16 offset:3592
    ds_read_b64_tr_b16 a[30:31], v16 offset:3584
    s_waitcnt vmcnt(4)
    ds_write_b128 v3, v[32:35]
    ds_write_b128 v3, v[36:39] offset:1024
    s_lshl_b32 s32, s19, 4
    s_lshr_b32 s24, s24, s32
    s_lshl_b32 s24, s24, 16
    s_waitcnt lgkmcnt(0)
    s_barrier
    s_and_b32 s8, s2, 7
    s_lshr_b32 s8, s8, 1
    s_lshr_b32 s9, s2, 3
    s_cmp_ge_u32 s9, 14
    s_cselect_b32 s12, s90, s88
    s_cselect_b32 s13, s91, s89
    s_cselect_b32 s36, 14, 0
    s_cselect_b32 s68, 28, 0
    s_sub_u32 s36, s9, s36
    s_and_b32 s69, s2, 1
    s_mul_i32 s69, s69, 14
    s_add_u32 s36, s36, s69
    s_add_u32 s68, s68, s36
    s_mov_b32 s14, 0x1c0000
    s_cmp_ge_u32 s9, 28
    s_cselect_b32 s14, 0, s14
    s_cselect_b32 s70, 1, 0
    s_mov_b32 s15, 0x20000
    s_mov_b32 s71, s8
    s_mul_i32 s37, s8, 458752
    s_lshl_b32 s36, s36, 7
    s_add_u32 s37, s37, s36
    v_lshrrev_b32 v125, 3, v124
    v_and_b32 v126, 7, v124
    v_mul_u32_u24 v127, 3584, v125
    v_lshl_add_u32 v127, v126, 4, v127
    buffer_load_dwordx4 v[128:131], v127, s[12:15], s37 offen
    s_add_u32 s37, s37, 114688
    buffer_load_dwordx4 v[132:135], v127, s[12:15], s37 offen
    s_add_u32 s37, s37, 114688
    buffer_load_dwordx4 v[136:139], v127, s[12:15], s37 offen
    s_add_u32 s37, s37, 114688
    buffer_load_dwordx4 v[140:143], v127, s[12:15], s37 offen
    s_mov_b32 s12, s92
    s_mov_b32 s13, s93
    s_mov_b32 s14, 0x1c0000
    s_mov_b32 s15, 0x20000
    s_lshr_b32 s36, s2, 1
    s_lshl_b32 s36, s36, 14
    s_and_b32 s37, s2, 1
    s_lshl_b32 s37, s37, 9
    s_add_u32 s36, s36, s37
    s_lshl_b32 s37, s18, 12
    s_add_u32 s36, s36, s37
    v_lshrrev_b32 v127, 5, v1
    v_lshlrev_b32 v127, 10, v127
    v_and_b32 v3, 31, v1
    v_lshl_add_u32 v127, v3, 4, v127
    s_lshl_b32 s37, s18, 11
    s_add_u32 m0, s37, 125440
    s_add_u32 s38, s36, 2048
    buffer_load_dwordx4 v127, s[12:15], s36 offen lds
    s_add_u32 m0, s37, 126464
    s_nop 0
    buffer_load_dwordx4 v127, s[12:15], s38 offen lds
    ds_read_b128 a[32:35], v17 offset:192
    ds_read_b128 a[36:39], v17 offset:704
    ds_read_b128 a[40:43], v17 offset:1216
    ds_read_b128 a[44:47], v17 offset:1728
    ds_read_b128 a[48:51], v17 offset:2240
    ds_read_b128 a[52:55], v17 offset:2752
    ds_read_b128 a[56:59], v17 offset:3264
    ds_read_b128 a[60:63], v17 offset:3776
    s_waitcnt lgkmcnt(0)
    v_mfma_f32_16x16x32_f16 v[64:67], a[0:3], a[32:35], 0
    ds_read_b64_tr_b16 a[64:65], v16 offset:72
    v_mfma_f32_16x16x32_f16 v[68:71], a[0:3], a[36:39], 0
    ds_read_b64_tr_b16 a[66:67], v16 offset:64
    v_mfma_f32_16x16x32_f16 v[72:75], a[0:3], a[40:43], 0
    ds_read_b128 a[96:99], v17 offset:128
    v_mfma_f32_16x16x32_f16 v[76:79], a[0:3], a[44:47], 0
    ds_read_b128 a[100:103], v17 offset:640
    v_mfma_f32_16x16x32_f16 v[80:83], a[0:3], a[48:51], 0
    ds_read_b128 a[104:107], v17 offset:1152
    v_mfma_f32_16x16x32_f16 v[84:87], a[0:3], a[52:55], 0
    ds_read_b128 a[108:111], v17 offset:1664
    v_mfma_f32_16x16x32_f16 v[88:91], a[0:3], a[56:59], 0
    ds_read_b128 a[112:115], v17 offset:2176
    v_mfma_f32_16x16x32_f16 v[92:95], a[0:3], a[60:63], 0
    ds_read_b128 a[116:119], v17 offset:2688
    v_mfma_f32_16x16x32_f16 v[68:71], a[4:7], a[32:35], v[68:71]
    ds_read_b128 a[120:123], v17 offset:3200
    v_mfma_f32_16x16x32_f16 v[72:75], a[4:7], a[36:39], v[72:75]
    ds_read_b128 a[124:127], v17 offset:3712
    v_mfma_f32_16x16x32_f16 v[76:79], a[4:7], a[40:43], v[76:79]
    ds_read_b64_tr_b16 a[68:69], v16 offset:584
    v_mfma_f32_16x16x32_f16 v[80:83], a[4:7], a[44:47], v[80:83]
    ds_read_b64_tr_b16 a[70:71], v16 offset:576
    v_mfma_f32_16x16x32_f16 v[84:87], a[4:7], a[48:51], v[84:87]
    s_waitcnt lgkmcnt(11)
    ds_read_b64_tr_b16 a[72:73], v16 offset:1096
    v_mfma_f32_16x16x32_f16 v[88:91], a[4:7], a[52:55], v[88:91]
    s_waitcnt lgkmcnt(11)
    ds_read_b64_tr_b16 a[74:75], v16 offset:1088
    v_mfma_f32_16x16x32_f16 v[92:95], a[4:7], a[56:59], v[92:95]
    s_waitcnt lgkmcnt(11)
    ds_read_b64_tr_b16 a[76:77], v16 offset:1608
    v_mfma_f32_16x16x32_f16 v[72:75], a[8:11], a[32:35], v[72:75]
    s_waitcnt lgkmcnt(11)
    ds_read_b64_tr_b16 a[78:79], v16 offset:1600
    v_mfma_f32_16x16x32_f16 v[76:79], a[8:11], a[36:39], v[76:79]
    s_waitcnt lgkmcnt(11)
    ds_read_b64_tr_b16 a[80:81], v16 offset:2120
    v_mfma_f32_16x16x32_f16 v[80:83], a[8:11], a[40:43], v[80:83]
    s_waitcnt lgkmcnt(11)
    ds_read_b64_tr_b16 a[82:83], v16 offset:2112
    v_mfma_f32_16x16x32_f16 v[84:87], a[8:11], a[44:47], v[84:87]
    s_waitcnt lgkmcnt(11)
    ds_read_b64_tr_b16 a[84:85], v16 offset:2632
    v_mfma_f32_16x16x32_f16 v[88:91], a[8:11], a[48:51], v[88:91]
    s_waitcnt lgkmcnt(11)
    ds_read_b64_tr_b16 a[86:87], v16 offset:2624
    v_mfma_f32_16x16x32_f16 v[92:95], a[8:11], a[52:55], v[92:95]
    s_waitcnt lgkmcnt(11)
    ds_read_b64_tr_b16 a[88:89], v16 offset:3144
    v_mfma_f32_16x16x32_f16 v[76:79], a[12:15], a[32:35], v[76:79]
    s_waitcnt lgkmcnt(11)
    ds_read_b64_tr_b16 a[90:91], v16 offset:3136
    v_mfma_f32_16x16x32_f16 v[80:83], a[12:15], a[36:39], v[80:83]
    s_waitcnt lgkmcnt(11)
    ds_read_b64_tr_b16 a[92:93], v16 offset:3656
    v_mfma_f32_16x16x32_f16 v[84:87], a[12:15], a[40:43], v[84:87]
    s_waitcnt lgkmcnt(11)
    ds_read_b64_tr_b16 a[94:95], v16 offset:3648
    v_mfma_f32_16x16x32_f16 v[88:91], a[12:15], a[44:47], v[88:91]
    v_mfma_f32_16x16x32_f16 v[92:95], a[12:15], a[48:51], v[92:95]
    v_mfma_f32_16x16x32_f16 v[80:83], a[16:19], a[32:35], v[80:83]
    v_mfma_f32_16x16x32_f16 v[84:87], a[16:19], a[36:39], v[84:87]
    v_mfma_f32_16x16x32_f16 v[88:91], a[16:19], a[40:43], v[88:91]
    v_mfma_f32_16x16x32_f16 v[92:95], a[16:19], a[44:47], v[92:95]
    v_mfma_f32_16x16x32_f16 v[84:87], a[20:23], a[32:35], v[84:87]
    v_mfma_f32_16x16x32_f16 v[88:91], a[20:23], a[36:39], v[88:91]
    v_mfma_f32_16x16x32_f16 v[92:95], a[20:23], a[40:43], v[92:95]
    v_mfma_f32_16x16x32_f16 v[88:91], a[24:27], a[32:35], v[88:91]
    v_mfma_f32_16x16x32_f16 v[92:95], a[24:27], a[36:39], v[92:95]
    v_mfma_f32_16x16x32_f16 v[92:95], a[28:31], a[32:35], v[92:95]
    s_waitcnt lgkmcnt(0)
    v_mfma_f32_16x16x32_f16 v[64:67], a[64:67], a[96:99], v[64:67]
    ds_read_b64_tr_b16 a[0:1], v16 offset:136
    v_mfma_f32_16x16x32_f16 v[68:71], a[64:67], a[100:103], v[68:71]
    ds_read_b64_tr_b16 a[2:3], v16 offset:128
    v_mfma_f32_16x16x32_f16 v[72:75], a[64:67], a[104:107], v[72:75]
    ds_read_b128 a[32:35], v17 offset:64
    v_mfma_f32_16x16x32_f16 v[76:79], a[64:67], a[108:111], v[76:79]
    ds_read_b128 a[36:39], v17 offset:576
    v_mfma_f32_16x16x32_f16 v[80:83], a[64:67], a[112:115], v[80:83]
    ds_read_b128 a[40:43], v17 offset:1088
    v_mfma_f32_16x16x32_f16 v[84:87], a[64:67], a[116:119], v[84:87]
    ds_read_b128 a[44:47], v17 offset:1600
    v_mfma_f32_16x16x32_f16 v[88:91], a[64:67], a[120:123], v[88:91]
    ds_read_b128 a[48:51], v17 offset:2112
    v_mfma_f32_16x16x32_f16 v[92:95], a[64:67], a[124:127], v[92:95]
    ds_read_b128 a[52:55], v17 offset:2624
    v_mfma_f32_16x16x32_f16 v[68:71], a[68:71], a[96:99], v[68:71]
    ds_read_b128 a[56:59], v17 offset:3136
    v_mfma_f32_16x16x32_f16 v[72:75], a[68:71], a[100:103], v[72:75]
    ds_read_b128 a[60:63], v17 offset:3648
    v_mfma_f32_16x16x32_f16 v[76:79], a[68:71], a[104:107], v[76:79]
    ds_read_b64_tr_b16 a[4:5], v16 offset:648
    v_mfma_f32_16x16x32_f16 v[80:83], a[68:71], a[108:111], v[80:83]
    ds_read_b64_tr_b16 a[6:7], v16 offset:640
    v_mfma_f32_16x16x32_f16 v[84:87], a[68:71], a[112:115], v[84:87]
    s_waitcnt lgkmcnt(11)
    ds_read_b64_tr_b16 a[8:9], v16 offset:1160
    v_mfma_f32_16x16x32_f16 v[88:91], a[68:71], a[116:119], v[88:91]
    s_waitcnt lgkmcnt(11)
    ds_read_b64_tr_b16 a[10:11], v16 offset:1152
    v_mfma_f32_16x16x32_f16 v[92:95], a[68:71], a[120:123], v[92:95]
    s_waitcnt lgkmcnt(11)
    ds_read_b64_tr_b16 a[12:13], v16 offset:1672
    v_mfma_f32_16x16x32_f16 v[72:75], a[72:75], a[96:99], v[72:75]
    s_waitcnt lgkmcnt(11)
    ds_read_b64_tr_b16 a[14:15], v16 offset:1664
    v_mfma_f32_16x16x32_f16 v[76:79], a[72:75], a[100:103], v[76:79]
    s_waitcnt lgkmcnt(11)
    ds_read_b64_tr_b16 a[16:17], v16 offset:2184
    v_mfma_f32_16x16x32_f16 v[80:83], a[72:75], a[104:107], v[80:83]
    s_waitcnt lgkmcnt(11)
    ds_read_b64_tr_b16 a[18:19], v16 offset:2176
    v_mfma_f32_16x16x32_f16 v[84:87], a[72:75], a[108:111], v[84:87]
    s_waitcnt lgkmcnt(11)
    ds_read_b64_tr_b16 a[20:21], v16 offset:2696
    v_mfma_f32_16x16x32_f16 v[88:91], a[72:75], a[112:115], v[88:91]
    s_waitcnt lgkmcnt(11)
    ds_read_b64_tr_b16 a[22:23], v16 offset:2688
    v_mfma_f32_16x16x32_f16 v[92:95], a[72:75], a[116:119], v[92:95]
    s_waitcnt lgkmcnt(11)
    ds_read_b64_tr_b16 a[24:25], v16 offset:3208
    v_mfma_f32_16x16x32_f16 v[76:79], a[76:79], a[96:99], v[76:79]
    s_waitcnt lgkmcnt(11)
    ds_read_b64_tr_b16 a[26:27], v16 offset:3200
    v_mfma_f32_16x16x32_f16 v[80:83], a[76:79], a[100:103], v[80:83]
    s_waitcnt lgkmcnt(11)
    ds_read_b64_tr_b16 a[28:29], v16 offset:3720
    v_mfma_f32_16x16x32_f16 v[84:87], a[76:79], a[104:107], v[84:87]
    s_waitcnt lgkmcnt(11)
    ds_read_b64_tr_b16 a[30:31], v16 offset:3712
    v_mfma_f32_16x16x32_f16 v[88:91], a[76:79], a[108:111], v[88:91]
    v_mfma_f32_16x16x32_f16 v[92:95], a[76:79], a[112:115], v[92:95]
    v_mfma_f32_16x16x32_f16 v[80:83], a[80:83], a[96:99], v[80:83]
    v_mfma_f32_16x16x32_f16 v[84:87], a[80:83], a[100:103], v[84:87]
    v_mfma_f32_16x16x32_f16 v[88:91], a[80:83], a[104:107], v[88:91]
    v_mfma_f32_16x16x32_f16 v[92:95], a[80:83], a[108:111], v[92:95]
    v_mfma_f32_16x16x32_f16 v[84:87], a[84:87], a[96:99], v[84:87]
    v_mfma_f32_16x16x32_f16 v[88:91], a[84:87], a[100:103], v[88:91]
    v_mfma_f32_16x16x32_f16 v[92:95], a[84:87], a[104:107], v[92:95]
    v_mfma_f32_16x16x32_f16 v[88:91], a[88:91], a[96:99], v[88:91]
    v_mfma_f32_16x16x32_f16 v[92:95], a[88:91], a[100:103], v[92:95]
    v_mfma_f32_16x16x32_f16 v[92:95], a[92:95], a[96:99], v[92:95]
    s_waitcnt lgkmcnt(0)
    v_mfma_f32_16x16x32_f16 v[64:67], a[0:3], a[32:35], v[64:67]
    ds_read_b64_tr_b16 a[64:65], v16 offset:200
    v_mfma_f32_16x16x32_f16 v[68:71], a[0:3], a[36:39], v[68:71]
    ds_read_b64_tr_b16 a[66:67], v16 offset:192
    v_mfma_f32_16x16x32_f16 v[72:75], a[0:3], a[40:43], v[72:75]
    ds_read_b128 a[96:99], v17 offset:0
    v_mfma_f32_16x16x32_f16 v[76:79], a[0:3], a[44:47], v[76:79]
    ds_read_b128 a[100:103], v17 offset:512
    v_mfma_f32_16x16x32_f16 v[80:83], a[0:3], a[48:51], v[80:83]
    ds_read_b128 a[104:107], v17 offset:1024
    v_mfma_f32_16x16x32_f16 v[84:87], a[0:3], a[52:55], v[84:87]
    ds_read_b128 a[108:111], v17 offset:1536
    v_mfma_f32_16x16x32_f16 v[88:91], a[0:3], a[56:59], v[88:91]
    ds_read_b128 a[112:115], v17 offset:2048
    v_mfma_f32_16x16x32_f16 v[92:95], a[0:3], a[60:63], v[92:95]
    ds_read_b128 a[116:119], v17 offset:2560
    v_mfma_f32_16x16x32_f16 v[68:71], a[4:7], a[32:35], v[68:71]
    ds_read_b128 a[120:123], v17 offset:3072
    v_mfma_f32_16x16x32_f16 v[72:75], a[4:7], a[36:39], v[72:75]
    ds_read_b128 a[124:127], v17 offset:3584
    v_mfma_f32_16x16x32_f16 v[76:79], a[4:7], a[40:43], v[76:79]
    ds_read_b64_tr_b16 a[68:69], v16 offset:712
    v_mfma_f32_16x16x32_f16 v[80:83], a[4:7], a[44:47], v[80:83]
    ds_read_b64_tr_b16 a[70:71], v16 offset:704
    v_mfma_f32_16x16x32_f16 v[84:87], a[4:7], a[48:51], v[84:87]
    s_waitcnt lgkmcnt(11)
    ds_read_b64_tr_b16 a[72:73], v16 offset:1224
    v_mfma_f32_16x16x32_f16 v[88:91], a[4:7], a[52:55], v[88:91]
    s_waitcnt lgkmcnt(11)
    ds_read_b64_tr_b16 a[74:75], v16 offset:1216
    v_mfma_f32_16x16x32_f16 v[92:95], a[4:7], a[56:59], v[92:95]
    s_waitcnt lgkmcnt(11)
    ds_read_b64_tr_b16 a[76:77], v16 offset:1736
    v_mfma_f32_16x16x32_f16 v[72:75], a[8:11], a[32:35], v[72:75]
    s_waitcnt lgkmcnt(11)
    ds_read_b64_tr_b16 a[78:79], v16 offset:1728
    v_mfma_f32_16x16x32_f16 v[76:79], a[8:11], a[36:39], v[76:79]
    s_waitcnt lgkmcnt(11)
    ds_read_b64_tr_b16 a[80:81], v16 offset:2248
    v_mfma_f32_16x16x32_f16 v[80:83], a[8:11], a[40:43], v[80:83]
    s_waitcnt lgkmcnt(11)
    ds_read_b64_tr_b16 a[82:83], v16 offset:2240
    v_mfma_f32_16x16x32_f16 v[84:87], a[8:11], a[44:47], v[84:87]
    s_waitcnt lgkmcnt(11)
    ds_read_b64_tr_b16 a[84:85], v16 offset:2760
    v_mfma_f32_16x16x32_f16 v[88:91], a[8:11], a[48:51], v[88:91]
    s_waitcnt lgkmcnt(11)
    ds_read_b64_tr_b16 a[86:87], v16 offset:2752
    v_mfma_f32_16x16x32_f16 v[92:95], a[8:11], a[52:55], v[92:95]
    s_waitcnt lgkmcnt(11)
    ds_read_b64_tr_b16 a[88:89], v16 offset:3272
    v_mfma_f32_16x16x32_f16 v[76:79], a[12:15], a[32:35], v[76:79]
    s_waitcnt lgkmcnt(11)
    ds_read_b64_tr_b16 a[90:91], v16 offset:3264
    v_mfma_f32_16x16x32_f16 v[80:83], a[12:15], a[36:39], v[80:83]
    s_waitcnt lgkmcnt(11)
    ds_read_b64_tr_b16 a[92:93], v16 offset:3784
    v_mfma_f32_16x16x32_f16 v[84:87], a[12:15], a[40:43], v[84:87]
    s_waitcnt lgkmcnt(11)
    ds_read_b64_tr_b16 a[94:95], v16 offset:3776
    v_mfma_f32_16x16x32_f16 v[88:91], a[12:15], a[44:47], v[88:91]
    v_mfma_f32_16x16x32_f16 v[92:95], a[12:15], a[48:51], v[92:95]
    v_mfma_f32_16x16x32_f16 v[80:83], a[16:19], a[32:35], v[80:83]
    v_mfma_f32_16x16x32_f16 v[84:87], a[16:19], a[36:39], v[84:87]
    v_mfma_f32_16x16x32_f16 v[88:91], a[16:19], a[40:43], v[88:91]
    v_mfma_f32_16x16x32_f16 v[92:95], a[16:19], a[44:47], v[92:95]
    v_mfma_f32_16x16x32_f16 v[84:87], a[20:23], a[32:35], v[84:87]
    v_mfma_f32_16x16x32_f16 v[88:91], a[20:23], a[36:39], v[88:91]
    v_mfma_f32_16x16x32_f16 v[92:95], a[20:23], a[40:43], v[92:95]
    v_mfma_f32_16x16x32_f16 v[88:91], a[24:27], a[32:35], v[88:91]
    v_mfma_f32_16x16x32_f16 v[92:95], a[24:27], a[36:39], v[92:95]
    v_mfma_f32_16x16x32_f16 v[92:95], a[28:31], a[32:35], v[92:95]
    s_waitcnt lgkmcnt(0)
    v_mfma_f32_16x16x32_f16 v[64:67], a[64:67], a[96:99], v[64:67]
    v_mfma_f32_16x16x32_f16 v[68:71], a[64:67], a[100:103], v[68:71]
    v_mfma_f32_16x16x32_f16 v[72:75], a[64:67], a[104:107], v[72:75]
    v_mfma_f32_16x16x32_f16 v[76:79], a[64:67], a[108:111], v[76:79]
    v_mfma_f32_16x16x32_f16 v[80:83], a[64:67], a[112:115], v[80:83]
    v_mfma_f32_16x16x32_f16 v[84:87], a[64:67], a[116:119], v[84:87]
    v_mfma_f32_16x16x32_f16 v[88:91], a[64:67], a[120:123], v[88:91]
    v_mfma_f32_16x16x32_f16 v[92:95], a[64:67], a[124:127], v[92:95]
    v_mfma_f32_16x16x32_f16 v[68:71], a[68:71], a[96:99], v[68:71]
    v_mfma_f32_16x16x32_f16 v[72:75], a[68:71], a[100:103], v[72:75]
    v_mfma_f32_16x16x32_f16 v[76:79], a[68:71], a[104:107], v[76:79]
    v_mfma_f32_16x16x32_f16 v[80:83], a[68:71], a[108:111], v[80:83]
    v_mfma_f32_16x16x32_f16 v[84:87], a[68:71], a[112:115], v[84:87]
    v_mfma_f32_16x16x32_f16 v[88:91], a[68:71], a[116:119], v[88:91]
    v_mfma_f32_16x16x32_f16 v[92:95], a[68:71], a[120:123], v[92:95]
    v_mfma_f32_16x16x32_f16 v[72:75], a[72:75], a[96:99], v[72:75]
    v_mfma_f32_16x16x32_f16 v[76:79], a[72:75], a[100:103], v[76:79]
    v_mfma_f32_16x16x32_f16 v[80:83], a[72:75], a[104:107], v[80:83]
    v_mfma_f32_16x16x32_f16 v[84:87], a[72:75], a[108:111], v[84:87]
    v_mfma_f32_16x16x32_f16 v[88:91], a[72:75], a[112:115], v[88:91]
    v_mfma_f32_16x16x32_f16 v[92:95], a[72:75], a[116:119], v[92:95]
    v_mfma_f32_16x16x32_f16 v[76:79], a[76:79], a[96:99], v[76:79]
    v_mfma_f32_16x16x32_f16 v[80:83], a[76:79], a[100:103], v[80:83]
    v_mfma_f32_16x16x32_f16 v[84:87], a[76:79], a[104:107], v[84:87]
    v_mfma_f32_16x16x32_f16 v[88:91], a[76:79], a[108:111], v[88:91]
    v_mfma_f32_16x16x32_f16 v[92:95], a[76:79], a[112:115], v[92:95]
    v_mfma_f32_16x16x32_f16 v[80:83], a[80:83], a[96:99], v[80:83]
    v_mfma_f32_16x16x32_f16 v[84:87], a[80:83], a[100:103], v[84:87]
    v_mfma_f32_16x16x32_f16 v[88:91], a[80:83], a[104:107], v[88:91]
    v_mfma_f32_16x16x32_f16 v[92:95], a[80:83], a[108:111], v[92:95]
    v_mfma_f32_16x16x32_f16 v[84:87], a[84:87], a[96:99], v[84:87]
    v_mfma_f32_16x16x32_f16 v[88:91], a[84:87], a[100:103], v[88:91]
    v_mfma_f32_16x16x32_f16 v[92:95], a[84:87], a[104:107], v[92:95]
    v_mfma_f32_16x16x32_f16 v[88:91], a[88:91], a[96:99], v[88:91]
    v_mfma_f32_16x16x32_f16 v[92:95], a[88:91], a[100:103], v[92:95]
    v_mfma_f32_16x16x32_f16 v[92:95], a[92:95], a[96:99], v[92:95]
    s_lshl_b32 s4, s18, 12
    s_add_u32 s4, s4, 33792
    v_add_u32 v2, s4, v19
    s_xor_b32 s5, s18, 1
    s_lshl_b32 s5, s5, 12
    s_add_u32 s5, s5, 33792
    v_add_u32 v3, s5, v19
    s_cmp_eq_u32 s20, 1
    s_cbranch_scc1 sequential_preLN__ssm_conv_s4d__geglu_ffn__prompt_kernel_nh1_9
    ds_write_b128 v2, v[80:83] offset:0
    ds_write_b128 v2, v[84:87] offset:1024
    ds_write_b128 v2, v[88:91] offset:2048
    ds_write_b128 v2, v[92:95] offset:3072
    s_branch sequential_preLN__ssm_conv_s4d__geglu_ffn__prompt_kernel_red_10
sequential_preLN__ssm_conv_s4d__geglu_ffn__prompt_kernel_nh1_9:
    ds_write_b128 v2, v[64:67] offset:0
    ds_write_b128 v2, v[68:71] offset:1024
    ds_write_b128 v2, v[72:75] offset:2048
    ds_write_b128 v2, v[76:79] offset:3072
    v_mov_b32 v64, v80
    v_mov_b32 v65, v81
    v_mov_b32 v66, v82
    v_mov_b32 v67, v83
    v_mov_b32 v68, v84
    v_mov_b32 v69, v85
    v_mov_b32 v70, v86
    v_mov_b32 v71, v87
    v_mov_b32 v72, v88
    v_mov_b32 v73, v89
    v_mov_b32 v74, v90
    v_mov_b32 v75, v91
    v_mov_b32 v76, v92
    v_mov_b32 v77, v93
    v_mov_b32 v78, v94
    v_mov_b32 v79, v95
sequential_preLN__ssm_conv_s4d__geglu_ffn__prompt_kernel_red_10:
    s_waitcnt lgkmcnt(0)
    s_barrier
    ds_read_b128 v[96:99], v3 offset:0
    ds_read_b128 v[100:103], v3 offset:1024
    ds_read_b128 v[104:107], v3 offset:2048
    ds_read_b128 v[108:111], v3 offset:3072
    ds_read_b64 v[112:113], v20 offset:0
    ds_read_b64 v[114:115], v20 offset:512
    ds_read_b64 v[116:117], v20 offset:1024
    ds_read_b64 v[118:119], v20 offset:1536
    s_mov_b32 s6, 0xffff0000
    s_waitcnt vmcnt(6) lgkmcnt(0)
    v_pk_add_f32 v[32:33], v[64:65], v[96:97]
    v_pk_add_f32 v[38:39], v[66:67], v[98:99]
    v_pk_add_f32 v[44:45], v[68:69], v[100:101]
    v_pk_add_f32 v[50:51], v[70:71], v[102:103]
    v_lshlrev_b32 v34, 16, v24
    v_lshlrev_b32 v40, 16, v25
    v_lshlrev_b32 v46, 16, v26
    v_lshlrev_b32 v52, 16, v27
    v_and_b32 v35, s6, v24
    v_and_b32 v41, s6, v25
    v_and_b32 v47, s6, v26
    v_and_b32 v53, s6, v27
    v_fma_mix_f32 v34, v112, s24, v34 op_sel_hi:[1,0,0]
    v_fma_mix_f32 v40, v113, s24, v40 op_sel_hi:[1,0,0]
    v_fma_mix_f32 v46, v114, s24, v46 op_sel_hi:[1,0,0]
    v_fma_mix_f32 v52, v115, s24, v52 op_sel_hi:[1,0,0]
    v_fma_mix_f32 v35, v112, s24, v35 op_sel:[1,0,0] op_sel_hi:[1,0,0]
    v_fma_mix_f32 v41, v113, s24, v41 op_sel:[1,0,0] op_sel_hi:[1,0,0]
    v_fma_mix_f32 v47, v114, s24, v47 op_sel:[1,0,0] op_sel_hi:[1,0,0]
    v_fma_mix_f32 v53, v115, s24, v53 op_sel:[1,0,0] op_sel_hi:[1,0,0]
    v_fma_f32 v32, v32, v22, v34
    v_fma_f32 v38, v38, v22, v40
    v_fma_f32 v44, v44, v22, v46
    v_fma_f32 v50, v50, v22, v52
    v_fma_f32 v33, v33, v22, v35
    v_fma_f32 v39, v39, v22, v41
    v_fma_f32 v45, v45, v22, v47
    v_fma_f32 v51, v51, v22, v53
    v_cvt_pk_bf16_f32 v56, v32, v33
    v_cvt_pk_bf16_f32 v57, v38, v39
    v_cvt_pk_bf16_f32 v58, v44, v45
    v_cvt_pk_bf16_f32 v59, v50, v51
    v_pk_add_f32 v[32:33], v[72:73], v[104:105]
    v_pk_add_f32 v[38:39], v[74:75], v[106:107]
    v_pk_add_f32 v[44:45], v[76:77], v[108:109]
    v_pk_add_f32 v[50:51], v[78:79], v[110:111]
    v_lshlrev_b32 v34, 16, v28
    v_lshlrev_b32 v40, 16, v29
    v_lshlrev_b32 v46, 16, v30
    v_lshlrev_b32 v52, 16, v31
    v_and_b32 v35, s6, v28
    v_and_b32 v41, s6, v29
    v_and_b32 v47, s6, v30
    v_and_b32 v53, s6, v31
    v_fma_mix_f32 v34, v116, s24, v34 op_sel_hi:[1,0,0]
    v_fma_mix_f32 v40, v117, s24, v40 op_sel_hi:[1,0,0]
    v_fma_mix_f32 v46, v118, s24, v46 op_sel_hi:[1,0,0]
    v_fma_mix_f32 v52, v119, s24, v52 op_sel_hi:[1,0,0]
    v_fma_mix_f32 v35, v116, s24, v35 op_sel:[1,0,0] op_sel_hi:[1,0,0]
    v_fma_mix_f32 v41, v117, s24, v41 op_sel:[1,0,0] op_sel_hi:[1,0,0]
    v_fma_mix_f32 v47, v118, s24, v47 op_sel:[1,0,0] op_sel_hi:[1,0,0]
    v_fma_mix_f32 v53, v119, s24, v53 op_sel:[1,0,0] op_sel_hi:[1,0,0]
    v_fma_f32 v32, v32, v22, v34
    v_fma_f32 v38, v38, v22, v40
    v_fma_f32 v44, v44, v22, v46
    v_fma_f32 v50, v50, v22, v52
    v_fma_f32 v33, v33, v22, v35
    v_fma_f32 v39, v39, v22, v41
    v_fma_f32 v45, v45, v22, v47
    v_fma_f32 v51, v51, v22, v53
    v_cvt_pk_bf16_f32 v60, v32, v33
    v_cvt_pk_bf16_f32 v61, v38, v39
    v_cvt_pk_bf16_f32 v62, v44, v45
    v_cvt_pk_bf16_f32 v63, v50, v51
    v_and_b32 v2, 1, v6
    v_lshrrev_b32 v3, 1, v6
    v_lshlrev_b32 v2, 9, v2
    v_lshl_add_u32 v2, v3, 4, v2
    v_lshl_add_u32 v2, v5, 5, v2
    v_permlane16_swap_b32 v56, v58
    v_permlane16_swap_b32 v57, v59
    v_permlane16_swap_b32 v60, v62
    v_permlane16_swap_b32 v61, v63
    buffer_store_dwordx4 v[56:59], v2, s[52:55], s25 offen offset:0 sc1
    buffer_store_dwordx4 v[60:63], v2, s[52:55], s25 offen offset:1024 sc1
    s_waitcnt vmcnt(0) lgkmcnt(0)
    s_barrier
    s_cmp_lg_u32 s18, 0
    s_cbranch_scc1 sequential_preLN__ssm_conv_s4d__geglu_ffn__prompt_kernel_nosig3_11
    s_add_u32 s56, s16, 0xfd0000
    s_addc_u32 s57, s17, 0
    s_mov_b32 s58, 0x10000
    s_mov_b32 s59, 0x20000
    v_mov_b32 v2, s98
    v_lshlrev_b32 v3, 10, v1
    s_lshl_b32 s33, s2, 2
    buffer_store_dword v2, v3, s[56:59], s33 offen sc1
sequential_preLN__ssm_conv_s4d__geglu_ffn__prompt_kernel_nosig3_11:
    s_waitcnt vmcnt(63)
    v_mov_b32 v32, 0
    v_mov_b32 v33, 0
    v_mov_b32 v34, 0
    v_mov_b32 v35, 0
    v_mov_b32 v36, 0
    v_mov_b32 v37, 0
    v_mov_b32 v38, 0
    v_mov_b32 v39, 0
    s_mov_b32 s26, 0xffff0000
    v_lshlrev_b32 v56, 16, v128
    v_lshlrev_b32 v58, 16, v129
    v_lshlrev_b32 v60, 16, v130
    v_lshlrev_b32 v62, 16, v131
    v_and_b32 v57, s26, v128
    v_and_b32 v59, s26, v129
    v_and_b32 v61, s26, v130
    v_and_b32 v63, s26, v131
    v_pk_add_f32 v[32:33], v[32:33], v[56:57]
    v_pk_add_f32 v[34:35], v[34:35], v[58:59]
    v_pk_add_f32 v[36:37], v[36:37], v[60:61]
    v_pk_add_f32 v[38:39], v[38:39], v[62:63]
    v_lshlrev_b32 v56, 16, v132
    v_lshlrev_b32 v58, 16, v133
    v_lshlrev_b32 v60, 16, v134
    v_lshlrev_b32 v62, 16, v135
    v_and_b32 v57, s26, v132
    v_and_b32 v59, s26, v133
    v_and_b32 v61, s26, v134
    v_and_b32 v63, s26, v135
    v_pk_add_f32 v[32:33], v[32:33], v[56:57]
    v_pk_add_f32 v[34:35], v[34:35], v[58:59]
    v_pk_add_f32 v[36:37], v[36:37], v[60:61]
    v_pk_add_f32 v[38:39], v[38:39], v[62:63]
    v_lshlrev_b32 v56, 16, v136
    v_lshlrev_b32 v58, 16, v137
    v_lshlrev_b32 v60, 16, v138
    v_lshlrev_b32 v62, 16, v139
    v_and_b32 v57, s26, v136
    v_and_b32 v59, s26, v137
    v_and_b32 v61, s26, v138
    v_and_b32 v63, s26, v139
    v_pk_add_f32 v[32:33], v[32:33], v[56:57]
    v_pk_add_f32 v[34:35], v[34:35], v[58:59]
    v_pk_add_f32 v[36:37], v[36:37], v[60:61]
    v_pk_add_f32 v[38:39], v[38:39], v[62:63]
    v_lshlrev_b32 v56, 16, v140
    v_lshlrev_b32 v58, 16, v141
    v_lshlrev_b32 v60, 16, v142
    v_lshlrev_b32 v62, 16, v143
    v_and_b32 v57, s26, v140
    v_and_b32 v59, s26, v141
    v_and_b32 v61, s26, v142
    v_and_b32 v63, s26, v143
    v_pk_add_f32 v[32:33], v[32:33], v[56:57]
    v_pk_add_f32 v[34:35], v[34:35], v[58:59]
    v_pk_add_f32 v[36:37], v[36:37], v[60:61]
    v_pk_add_f32 v[38:39], v[38:39], v[62:63]
    v_mul_u32_u24 v4, 1152, v126
    v_lshlrev_b32 v56, 2, v126
    v_xor_b32 v56, v56, v125
    v_lshl_add_u32 v4, v56, 2, v4
    v_add_u32 v4, 17408, v4
    ds_write_b32 v4, v32 offset:0
    ds_write_b32 v4, v33 offset:144
    ds_write_b32 v4, v34 offset:288
    ds_write_b32 v4, v35 offset:432
    ds_write_b32 v4, v36 offset:576
    ds_write_b32 v4, v37 offset:720
    ds_write_b32 v4, v38 offset:864
    ds_write_b32 v4, v39 offset:1008
    s_waitcnt lgkmcnt(0)
    s_barrier
    v_lshrrev_b32 v42, 5, v1
    v_bfe_u32 v43, v1, 2, 2
    v_lshl_add_u32 v42, v42, 3, v43
    v_lshlrev_b32 v42, 9, v42
    v_bfe_u32 v43, v1, 4, 1
    v_lshl_add_u32 v42, v43, 5, v42
    v_and_b32 v43, 3, v1
    v_lshl_add_u32 v42, v43, 3, v42
    s_lshl_b32 s34, s18, 7
    s_add_u32 s34, s34, 125440
    v_add_u32 v42, s34, v42
    ds_read_b64_tr_b16 v[44:45], v42 offset:0
    ds_read_b64_tr_b16 v[46:47], v42 offset:2048
    ds_read_b64_tr_b16 v[48:49], v42 offset:64
    ds_read_b64_tr_b16 v[50:51], v42 offset:2112
    s_add_u32 s12, s16, 0x600000
    s_addc_u32 s13, s17, 0
    s_mov_b32 s14, 0x1c0000
    s_mov_b32 s15, 0x20000
    s_cmp_ge_u32 s2, 224
    s_cselect_b32 s14, 0, s14
    s_and_b32 s34, s2, 1
    s_lshl_b32 s34, s34, 3
    s_lshl_b32 s35, s18, 1
    s_add_u32 s34, s34, s35
    s_mul_i32 s34, s34, 112
    s_lshr_b32 s35, s2, 1
    s_add_u32 s34, s34, s35
    s_lshl_b32 s34, s34, 10
    s_add_u32 s35, s34, 114688
    v_lshlrev_b32 v43, 4, v1
    s_waitcnt lgkmcnt(2)
    buffer_store_dwordx4 v[44:47], v43, s[12:15], s34 offen sc1
    s_waitcnt lgkmcnt(0)
    buffer_store_dwordx4 v[48:51], v43, s[12:15], s35 offen sc1
    s_cmp_lg_u32 s18, 0
    s_cbranch_scc1 sequential_preLN__ssm_conv_s4d__geglu_ffn__prompt_kernel_nocol_12
    v_mul_u32_u24 v4, 144, v1
    v_add_u32 v4, 17408, v4
    ds_read_b128 v[8:11], v4 offset:0
    ds_read_b128 v[12:15], v4 offset:16
    ds_read_b128 v[16:19], v4 offset:32
    ds_read_b128 v[20:23], v4 offset:48
    ds_read_b128 v[24:27], v4 offset:64
    ds_read_b128 v[28:31], v4 offset:80
    ds_read_b128 v[32:35], v4 offset:96
    ds_read_b128 v[36:39], v4 offset:112
    s_waitcnt lgkmcnt(0)
    v_pk_add_f32 v[8:9], v[8:9], v[24:25]
    v_pk_add_f32 v[10:11], v[10:11], v[26:27]
    v_pk_add_f32 v[12:13], v[12:13], v[28:29]
    v_pk_add_f32 v[14:15], v[14:15], v[30:31]
    v_pk_add_f32 v[16:17], v[16:17], v[32:33]
    v_pk_add_f32 v[18:19], v[18:19], v[34:35]
    v_pk_add_f32 v[20:21], v[20:21], v[36:37]
    v_pk_add_f32 v[22:23], v[22:23], v[38:39]
    v_pk_add_f32 v[8:9], v[8:9], v[16:17]
    v_pk_add_f32 v[10:11], v[10:11], v[18:19]
    v_pk_add_f32 v[12:13], v[12:13], v[20:21]
    v_pk_add_f32 v[14:15], v[14:15], v[22:23]
    v_pk_add_f32 v[8:9], v[8:9], v[12:13]
    v_pk_add_f32 v[10:11], v[10:11], v[14:15]
    v_pk_add_f32 v[8:9], v[8:9], v[10:11]
    v_add_f32 v8, v8, v9
    s_add_u32 s12, s16, 0x7c0000
    s_addc_u32 s13, s17, 0
    s_mov_b32 s14, 0xe000
    s_mov_b32 s15, 0x20000
    s_cmp_eq_u32 s70, 1
    s_cselect_b32 s14, 0, s14
    s_mul_i32 s34, s71, 14336
    s_lshl_b32 s35, s68, 8
    s_add_u32 s34, s34, s35
    v_lshlrev_b32 v4, 2, v1
    buffer_store_dword v8, v4, s[12:15], s34 offen sc1
sequential_preLN__ssm_conv_s4d__geglu_ffn__prompt_kernel_nocol_12:
    s_waitcnt lgkmcnt(0)
    s_barrier
    s_load_dwordx4 s[4:7], s[0:1], 64
    s_load_dwordx2 s[8:9], s[0:1], 104
    s_load_dwordx2 s[10:11], s[0:1], 88
    s_and_b32 s23, s2, 7
    s_lshr_b32 s22, s2, 3
    s_sub_u32 s24, s22, 4
    s_mul_i32 s25, s24, 37
    s_lshr_b32 s25, s25, 8
    s_mul_i32 s26, s25, 7
    s_sub_u32 s26, s24, s26
    s_cmp_lt_u32 s22, 4
    s_cselect_b32 s25, s22, s25
    s_cselect_b32 s26, 7, s26
    s_lshr_b32 s20, s23, 1
    s_lshl_b32 s20, s20, 2
    s_add_u32 s20, s20, s25
    s_and_b32 s19, s23, 1
    s_mul_i32 s21, s19, 7
    s_add_u32 s21, s21, s26
    s_lshr_b32 s27, s22, 3
    s_lshl_b32 s12, s23, 2
    s_add_u32 s12, s12, s27
    s_and_b32 s13, s22, 7
    v_lshrrev_b32 v2, 6, v0
    v_and_b32 v1, 63, v0
    v_readfirstlane_b32 s18, v2
    s_nop 3
    s_lshr_b32 s16, s18, 1
    s_and_b32 s17, s18, 1
    v_lshrrev_b32 v2, 4, v1
    v_and_b32 v5, 15, v1
    v_lshrrev_b32 v6, 1, v5
    v_and_b32 v7, 1, v5
    v_lshlrev_b32 v7, 4, v7
    s_lshl_b32 s26, s18, 3
    v_add_u32 v11, s26, v2
    v_mul_u32_u24 v12, 3584, v11
    s_lshl_b32 s27, s21, 8
    v_add_u32 v12, s27, v12
    v_add_u32 v12, v12, v7
    v_xor_b32 v7, v6, v2
    v_lshl_add_u32 v8, v7, 5, v12
    v_xor_b32 v7, 4, v7
    v_lshl_add_u32 v9, v7, 5, v12
    v_lshlrev_b32 v12, 12, v11
    s_lshl_b32 s27, s20, 8
    v_add_u32 v12, s27, v12
    v_and_b32 v7, 3, v5
    v_lshl_add_u32 v12, v7, 4, v12
    v_lshrrev_b32 v7, 2, v5
    v_xor_b32 v7, v7, v2
    v_lshl_add_u32 v10, v7, 6, v12
    s_lshl_b32 s53, s18, 11
    s_lshr_b32 s88, s23, 1
    s_lshl_b32 s88, s88, 2
    s_waitcnt lgkmcnt(0)
    s_add_u32 s36, s8, 0x400000
    s_addc_u32 s37, s9, 0
    s_mov_b32 s38, 0x200000
    s_mov_b32 s39, 0x20000
    s_mov_b32 s28, s4
    s_mov_b32 s29, s5
    s_mov_b32 s30, 0x1c0000
    s_mov_b32 s31, 0x20000
    s_mov_b32 s32, s6
    s_mov_b32 s33, s7
    s_mov_b32 s34, 0x1c0000
    s_mov_b32 s35, 0x20000
    s_cmp_lt_u32 s22, 4
    s_cbranch_scc1 sequential_preLN__ssm_conv_s4d__geglu_ffn__prompt_kernel_f_helper
    s_lshl_b32 s89, s88, 17
    s_mul_i32 s90, s88, 114688
    v_add_u32 v15, 16384, v10
    v_add_u32 v29, 14336, v8
    v_add_u32 v30, 14336, v9
    s_lshl_b32 s91, s88, 17
    s_sub_u32 s91, s91, 131072
    s_add_u32 s92, s88, 0
    s_and_b32 s92, s92, 15
    s_mul_i32 s92, s92, 114688
    s_add_u32 m0, s53, 0
    s_nop 0
    buffer_load_dwordx4 v8, s[28:31], s92 offen lds
    s_add_u32 m0, s53, 8192
    s_nop 0
    buffer_load_dwordx4 v9, s[32:35], s92 offen lds
    s_add_u32 m0, s53, 1024
    s_nop 0
    buffer_load_dwordx4 v29, s[28:31], s92 offen lds
    s_add_u32 m0, s53, 9216
    s_nop 0
    buffer_load_dwordx4 v30, s[32:35], s92 offen lds
    s_add_u32 s92, s88, 1
    s_and_b32 s92, s92, 15
    s_mul_i32 s92, s92, 114688
    s_add_u32 m0, s53, 24576
    s_nop 0
    buffer_load_dwordx4 v8, s[28:31], s92 offen lds
    s_add_u32 m0, s53, 32768
    s_nop 0
    buffer_load_dwordx4 v9, s[32:35], s92 offen lds
    s_add_u32 m0, s53, 25600
    s_nop 0
    buffer_load_dwordx4 v29, s[28:31], s92 offen lds
    s_add_u32 m0, s53, 33792
    s_nop 0
    buffer_load_dwordx4 v30, s[32:35], s92 offen lds
    s_add_u32 s92, s88, 2
    s_and_b32 s92, s92, 15
    s_mul_i32 s92, s92, 114688
    s_add_u32 m0, s53, 49152
    s_nop 0
    buffer_load_dwordx4 v8, s[28:31], s92 offen lds
    s_add_u32 m0, s53, 57344
    s_nop 0
    buffer_load_dwordx4 v9, s[32:35], s92 offen lds
    s_add_u32 m0, s53, 50176
    s_nop 0
    buffer_load_dwordx4 v29, s[28:31], s92 offen lds
    s_add_u32 m0, s53, 58368
    s_nop 0
    buffer_load_dwordx4 v30, s[32:35], s92 offen lds
    s_add_u32 s92, s88, 3
    s_and_b32 s92, s92, 15
    s_mul_i32 s92, s92, 114688
    s_add_u32 m0, s53, 73728
    s_nop 0
    buffer_load_dwordx4 v8, s[28:31], s92 offen lds
    s_add_u32 m0, s53, 81920
    s_nop 0
    buffer_load_dwordx4 v9, s[32:35], s92 offen lds
    s_add_u32 m0, s53, 74752
    s_nop 0
    buffer_load_dwordx4 v29, s[28:31], s92 offen lds
    s_add_u32 m0, s53, 82944
    s_nop 0
    buffer_load_dwordx4 v30, s[32:35], s92 offen lds
    s_add_u32 s92, s88, 4
    s_and_b32 s92, s92, 15
    s_mul_i32 s92, s92, 114688
    s_add_u32 m0, s53, 98304
    s_nop 0
    buffer_load_dwordx4 v8, s[28:31], s92 offen lds
    s_add_u32 m0, s53, 106496
    s_nop 0
    buffer_load_dwordx4 v9, s[32:35], s92 offen lds
    s_add_u32 m0, s53, 99328
    s_nop 0
    buffer_load_dwordx4 v29, s[28:31], s92 offen lds
    s_add_u32 m0, s53, 107520
    s_nop 0
    buffer_load_dwordx4 v30, s[32:35], s92 offen lds
    s_add_u32 s92, s88, 5
    s_and_b32 s92, s92, 15
    s_mul_i32 s92, s92, 114688
    s_add_u32 m0, s53, 122880
    s_nop 0
    buffer_load_dwordx4 v8, s[28:31], s92 offen lds
    s_add_u32 m0, s53, 131072
    s_nop 0
    buffer_load_dwordx4 v9, s[32:35], s92 offen lds
    s_add_u32 m0, s53, 123904
    s_nop 0
    buffer_load_dwordx4 v29, s[28:31], s92 offen lds
    s_add_u32 m0, s53, 132096
    s_nop 0
    buffer_load_dwordx4 v30, s[32:35], s92 offen lds
    s_add_u32 s40, s8, 0xfd0000
    s_addc_u32 s41, s9, 0
    s_mov_b32 s42, 0x10000
    s_mov_b32 s43, 0x20000
    s_cmp_lg_u32 s18, 0
    s_cbranch_scc1 sequential_preLN__ssm_conv_s4d__geglu_ffn__prompt_kernel_f3w_13
    s_and_b32 s26, s2, 7
    s_lshr_b32 s27, s2, 5
    s_lshl_b32 s27, s27, 3
    s_add_u32 s26, s26, s27
    s_lshl_b32 s26, s26, 10
    v_lshlrev_b32 v13, 4, v1
    s_mov_b32 s55, 1048576
sequential_preLN__ssm_conv_s4d__geglu_ffn__prompt_kernel_f3l_14:
    buffer_load_dwordx4 v[16:19], v13, s[40:43], s26 offen sc1
    s_waitcnt vmcnt(0)
    v_cmp_eq_u32 vcc, s98, v16
    v_cmp_eq_u32 s[50:51], s98, v17
    s_nop 3
    s_and_b64 vcc, vcc, s[50:51]
    v_cmp_eq_u32 s[50:51], s98, v18
    s_nop 3
    s_and_b64 vcc, vcc, s[50:51]
    v_cmp_eq_u32 s[50:51], s98, v19
    s_nop 3
    s_and_b64 vcc, vcc, s[50:51]
    s_cmp_eq_u64 vcc, exec
    s_cbranch_scc1 sequential_preLN__ssm_conv_s4d__geglu_ffn__prompt_kernel_f3w_13
    s_sub_u32 s55, s55, 1
    s_cmp_lg_u32 s55, 0
    s_cbranch_scc1 sequential_preLN__ssm_conv_s4d__geglu_ffn__prompt_kernel_f3l_14
sequential_preLN__ssm_conv_s4d__geglu_ffn__prompt_kernel_f3w_13:
    s_waitcnt vmcnt(24)
    s_barrier
    s_cmp_lg_u32 s18, 0
    s_cbranch_scc1 sequential_preLN__ssm_conv_s4d__geglu_ffn__prompt_kernel_nosig4_15
    s_add_u32 s40, s8, 0xfe0000
    s_addc_u32 s41, s9, 0
    s_mov_b32 s42, 0x10000
    s_mov_b32 s43, 0x20000
    v_mov_b32 v16, s98
    v_lshlrev_b32 v17, 10, v1
    s_lshl_b32 s26, s2, 2
    buffer_store_dword v16, v17, s[40:43], s26 offen sc1
sequential_preLN__ssm_conv_s4d__geglu_ffn__prompt_kernel_nosig4_15:
    s_cmp_lg_u32 s2, 0
    s_cbranch_scc1 sequential_preLN__ssm_conv_s4d__geglu_ffn__prompt_kernel_notok_16
    s_cmp_lg_u32 s18, 0
    s_cbranch_scc1 sequential_preLN__ssm_conv_s4d__geglu_ffn__prompt_kernel_notok_16
    s_add_u32 s40, s8, 0xfc0000
    s_addc_u32 s41, s9, 0
    s_mov_b32 s42, 0x4
    s_mov_b32 s43, 0x20000
    v_mov_b32 v16, s98
    v_mov_b32 v17, 0
    buffer_store_dword v16, v17, s[40:43], 0 offen sc1
sequential_preLN__ssm_conv_s4d__geglu_ffn__prompt_kernel_notok_16:
    s_add_u32 s91, s91, 131072
    s_and_b32 s91, s91, 0x1fffff
    s_add_u32 m0, s53, 16384
    s_nop 0
    buffer_load_dwordx4 v10, s[36:39], s91 offen sc1 lds
    s_add_u32 m0, s53, 17408
    s_nop 0
    buffer_load_dwordx4 v15, s[36:39], s91 offen sc1 lds
    s_add_u32 s91, s91, 131072
    s_and_b32 s91, s91, 0x1fffff
    s_add_u32 m0, s53, 40960
    s_nop 0
    buffer_load_dwordx4 v10, s[36:39], s91 offen sc1 lds
    s_add_u32 m0, s53, 41984
    s_nop 0
    buffer_load_dwordx4 v15, s[36:39], s91 offen sc1 lds
    s_add_u32 s91, s91, 131072
    s_and_b32 s91, s91, 0x1fffff
    s_add_u32 m0, s53, 65536
    s_nop 0
    buffer_load_dwordx4 v10, s[36:39], s91 offen sc1 lds
    s_add_u32 m0, s53, 66560
    s_nop 0
    buffer_load_dwordx4 v15, s[36:39], s91 offen sc1 lds
    s_add_u32 s91, s91, 131072
    s_and_b32 s91, s91, 0x1fffff
    s_add_u32 m0, s53, 90112
    s_nop 0
    buffer_load_dwordx4 v10, s[36:39], s91 offen sc1 lds
    s_add_u32 m0, s53, 91136
    s_nop 0
    buffer_load_dwordx4 v15, s[36:39], s91 offen sc1 lds
    s_add_u32 s40, s8, 0x7c0000
    s_addc_u32 s41, s9, 0
    s_mov_b32 s42, 0xe000
    s_mov_b32 s43, 0x20000
    s_add_u32 s44, s8, 0x800000
    s_addc_u32 s45, s9, 0
    s_mov_b32 s46, 0x700000
    s_mov_b32 s47, 0x20000
    s_add_u32 s56, s8, 0x600000
    s_addc_u32 s57, s9, 0
    s_mov_b32 s58, 0x1c0000
    s_mov_b32 s59, 0x20000
    s_add_u32 s60, s8, 0x7d0000
    s_addc_u32 s61, s9, 0
    s_mov_b32 s62, 0x8000
    s_mov_b32 s63, 0x20000
    s_add_u32 s64, s8, 0xf80000
    s_addc_u32 s65, s9, 0
    s_mov_b32 s66, 0x9000
    s_mov_b32 s67, 0x20000
    s_mov_b32 s68, s10
    s_mov_b32 s69, s11
    s_mov_b32 s70, 0x200000
    s_mov_b32 s71, 0x20000
    s_mul_i32 s14, s18, 28
    s_lshl_b32 s15, s13, 1
    s_mul_i32 s15, s15, 112
    s_add_u32 s14, s15, s14
    s_lshl_b32 s14, s14, 10
    s_add_u32 s15, s14, 114688
    v_lshlrev_b32 v3, 4, v1
    v_mov_b32 v4, 0
    s_lshr_b32 s95, s12, 1
    s_lshl_b32 s95, s95, 4
    s_and_b32 s26, s22, 15
    s_add_u32 s95, s95, s26
    s_lshl_b32 s95, s95, 7
    s_mov_b32 s93, 0
    s_lshl_b32 s26, s93, 12
    s_add_u32 s14, s14, s26
    s_add_u32 s15, s15, s26
    s_mov_b32 s94, s93
    v_lshrrev_b32 v2, 4, v1
    v_bfe_u32 v5, v1, 2, 2
    v_and_b32 v6, 3, v1
    v_lshrrev_b32 v7, 1, v2
    v_lshl_add_u32 v7, v7, 3, v5
    v_lshlrev_b32 v7, 8, v7
    v_and_b32 v11, 1, v2
    v_lshl_add_u32 v12, v11, 13, v7
    v_and_b32 v13, 1, v6
    v_lshl_add_u32 v12, v13, 4, v12
    v_lshrrev_b32 v13, 1, v6
    v_lshl_add_u32 v12, v13, 3, v12
    v_lshl_add_u32 v13, v11, 2, v5
    s_lshl_b32 s27, s17, 2
    s_add_u32 s26, s27, 0
    v_xor_b32 v14, s26, v13
    v_lshl_add_u32 v16, v14, 5, v12
    s_add_u32 s26, s27, 1
    v_xor_b32 v14, s26, v13
    v_lshl_add_u32 v17, v14, 5, v12
    s_add_u32 s26, s27, 2
    v_xor_b32 v14, s26, v13
    v_lshl_add_u32 v18, v14, 5, v12
    s_add_u32 s26, s27, 3
    v_xor_b32 v14, s26, v13
    v_lshl_add_u32 v19, v14, 5, v12
    v_lshl_add_u32 v12, v11, 5, v7
    v_lshl_add_u32 v12, v6, 3, v12
    v_add_u32 v12, 16384, v12
    s_lshl_b32 s27, s16, 1
    s_add_u32 s26, s27, 0
    v_xor_b32 v14, s26, v5
    v_lshl_add_u32 v20, v14, 6, v12
    s_add_u32 s26, s27, 1
    v_xor_b32 v14, s26, v5
    v_lshl_add_u32 v21, v14, 6, v12
    v_add_u32 v22, 73728, v16
    v_add_u32 v23, 73728, v17
    v_add_u32 v24, 73728, v18
    v_add_u32 v25, 73728, v19
    v_add_u32 v26, 73728, v20
    v_add_u32 v27, 73728, v21
    v_and_b32 v5, 31, v1
    s_lshl_b32 s26, s20, 7
    s_lshl_b32 s27, s16, 6
    s_add_u32 s26, s26, s27
    v_add_u32 v5, s26, v5
    v_lshlrev_b32 v5, 4, v5
    v_and_b32 v6, 127, v0
    v_lshrrev_b32 v7, 7, v0
    v_mul_u32_u24 v7, 1792, v7
    v_add_u32 v6, v6, v7
    s_lshl_b32 s27, s21, 7
    v_add_u32 v6, s27, v6
    v_lshlrev_b32 v6, 2, v6
    s_lshl_b32 s51, s20, 7
    s_add_u32 s51, s51, 32768
    s_add_u32 s60, s8, 0xfe0000
    s_addc_u32 s61, s9, 0
    s_mov_b32 s62, 0x10000
    s_mov_b32 s63, 0x20000
    s_and_b32 s26, s2, 7
    s_lshr_b32 s27, s2, 5
    s_lshl_b32 s27, s27, 3
    s_add_u32 s26, s26, s27
    s_lshl_b32 s99, s26, 10
    s_waitcnt vmcnt(6)
    s_barrier
    ds_read_b64_tr_b16 v[48:49], v20 offset:0
    ds_read_b64_tr_b16 v[50:51], v20 offset:1024
    ds_read_b64_tr_b16 v[52:53], v21 offset:0
    ds_read_b64_tr_b16 v[54:55], v21 offset:1024
    ds_read_b64_tr_b16 v[32:33], v16 offset:0
    ds_read_b64_tr_b16 v[34:35], v16 offset:1024
    ds_read_b64_tr_b16 v[36:37], v17 offset:0
    ds_read_b64_tr_b16 v[38:39], v17 offset:1024
    ds_read_b64_tr_b16 v[40:41], v18 offset:0
    ds_read_b64_tr_b16 v[42:43], v18 offset:1024
    ds_read_b64_tr_b16 v[44:45], v19 offset:0
    ds_read_b64_tr_b16 v[46:47], v19 offset:1024
    s_waitcnt lgkmcnt(0)
    v_mfma_f32_32x32x16_bf16 v[128:143], v[32:35], v[48:51], 0
    ds_read_b64_tr_b16 v[72:73], v20 offset:4096
    ds_read_b64_tr_b16 v[74:75], v20 offset:5120
    v_mfma_f32_32x32x16_bf16 v[144:159], v[32:35], v[52:55], 0
    s_add_u32 s91, s91, 131072
    s_and_b32 s91, s91, 0x1fffff
    s_add_u32 m0, s53, 114688
    ds_read_b64_tr_b16 v[76:77], v21 offset:4096
    ds_read_b64_tr_b16 v[78:79], v21 offset:5120
    buffer_load_dwordx4 v10, s[36:39], s91 offen sc1 lds
    v_mfma_f32_32x32x16_bf16 v[160:175], v[36:39], v[48:51], 0
    s_add_u32 m0, s53, 115712
    ds_read_b64_tr_b16 v[56:57], v16 offset:4096
    ds_read_b64_tr_b16 v[58:59], v16 offset:5120
    buffer_load_dwordx4 v15, s[36:39], s91 offen sc1 lds
    v_mfma_f32_32x32x16_bf16 v[176:191], v[36:39], v[52:55], 0
    s_add_u32 s91, s91, 131072
    s_and_b32 s91, s91, 0x1fffff
    s_add_u32 m0, s53, 139264
    ds_read_b64_tr_b16 v[60:61], v17 offset:4096
    ds_read_b64_tr_b16 v[62:63], v17 offset:5120
    buffer_load_dwordx4 v10, s[36:39], s91 offen sc1 lds
    v_mfma_f32_32x32x16_bf16 v[192:207], v[40:43], v[48:51], 0
    s_add_u32 m0, s53, 140288
    ds_read_b64_tr_b16 v[64:65], v18 offset:4096
    ds_read_b64_tr_b16 v[66:67], v18 offset:5120
    buffer_load_dwordx4 v15, s[36:39], s91 offen sc1 lds
    v_mfma_f32_32x32x16_bf16 v[208:223], v[40:43], v[52:55], 0
    ds_read_b64_tr_b16 v[68:69], v19 offset:4096
    ds_read_b64_tr_b16 v[70:71], v19 offset:5120
    v_mfma_f32_32x32x16_bf16 v[224:239], v[44:47], v[48:51], 0
    v_mfma_f32_32x32x16_bf16 v[240:255], v[44:47], v[52:55], 0
    s_waitcnt lgkmcnt(0)
    s_waitcnt vmcnt(8)
    s_barrier
    v_mfma_f32_32x32x16_bf16 v[128:143], v[56:59], v[72:75], v[128:143]
    ds_read_b64_tr_b16 v[48:49], v20 offset:24576
    ds_read_b64_tr_b16 v[50:51], v20 offset:25600
    v_mfma_f32_32x32x16_bf16 v[144:159], v[56:59], v[76:79], v[144:159]
    s_add_u32 s91, s91, 131072
    s_and_b32 s91, s91, 0x1fffff
    s_add_u32 m0, s53, 16384
    ds_read_b64_tr_b16 v[52:53], v21 offset:24576
    ds_read_b64_tr_b16 v[54:55], v21 offset:25600
    buffer_load_dwordx4 v10, s[36:39], s91 offen sc1 lds
    v_mfma_f32_32x32x16_bf16 v[160:175], v[60:63], v[72:75], v[160:175]
    s_add_u32 m0, s53, 17408
    ds_read_b64_tr_b16 v[32:33], v16 offset:24576
    ds_read_b64_tr_b16 v[34:35], v16 offset:25600
    buffer_load_dwordx4 v15, s[36:39], s91 offen sc1 lds
    v_mfma_f32_32x32x16_bf16 v[176:191], v[60:63], v[76:79], v[176:191]
    s_add_u32 s92, s88, 6
    s_and_b32 s92, s92, 15
    s_mul_i32 s92, s92, 114688
    s_add_u32 m0, s53, 0
    ds_read_b64_tr_b16 v[36:37], v17 offset:24576
    ds_read_b64_tr_b16 v[38:39], v17 offset:25600
    buffer_load_dwordx4 v8, s[28:31], s92 offen lds
    v_mfma_f32_32x32x16_bf16 v[192:207], v[64:67], v[72:75], v[192:207]
    s_add_u32 m0, s53, 8192
    ds_read_b64_tr_b16 v[40:41], v18 offset:24576
    ds_read_b64_tr_b16 v[42:43], v18 offset:25600
    buffer_load_dwordx4 v9, s[32:35], s92 offen lds
    v_mfma_f32_32x32x16_bf16 v[208:223], v[64:67], v[76:79], v[208:223]
    ds_read_b64_tr_b16 v[44:45], v19 offset:24576
    ds_read_b64_tr_b16 v[46:47], v19 offset:25600
    v_mfma_f32_32x32x16_bf16 v[224:239], v[68:71], v[72:75], v[224:239]
    v_mfma_f32_32x32x16_bf16 v[240:255], v[68:71], v[76:79], v[240:255]
    s_waitcnt lgkmcnt(0)
    v_mfma_f32_32x32x16_bf16 v[128:143], v[32:35], v[48:51], v[128:143]
    ds_read_b64_tr_b16 v[72:73], v20 offset:28672
    ds_read_b64_tr_b16 v[74:75], v20 offset:29696
    v_mfma_f32_32x32x16_bf16 v[144:159], v[32:35], v[52:55], v[144:159]
    s_add_u32 m0, s53, 1024
    ds_read_b64_tr_b16 v[76:77], v21 offset:28672
    ds_read_b64_tr_b16 v[78:79], v21 offset:29696
    buffer_load_dwordx4 v29, s[28:31], s92 offen lds
    v_mfma_f32_32x32x16_bf16 v[160:175], v[36:39], v[48:51], v[160:175]
    s_add_u32 m0, s53, 9216
    ds_read_b64_tr_b16 v[56:57], v16 offset:28672
    ds_read_b64_tr_b16 v[58:59], v16 offset:29696
    buffer_load_dwordx4 v30, s[32:35], s92 offen lds
    v_mfma_f32_32x32x16_bf16 v[176:191], v[36:39], v[52:55], v[176:191]
    ds_read_b64_tr_b16 v[60:61], v17 offset:28672
    ds_read_b64_tr_b16 v[62:63], v17 offset:29696
    buffer_load_dwordx4 v[92:95], v3, s[60:63], s99 offen sc1
    v_mfma_f32_32x32x16_bf16 v[192:207], v[40:43], v[48:51], v[192:207]
    ds_read_b64_tr_b16 v[64:65], v18 offset:28672
    ds_read_b64_tr_b16 v[66:67], v18 offset:29696
    v_mfma_f32_32x32x16_bf16 v[208:223], v[40:43], v[52:55], v[208:223]
    ds_read_b64_tr_b16 v[68:69], v19 offset:28672
    ds_read_b64_tr_b16 v[70:71], v19 offset:29696
    v_mfma_f32_32x32x16_bf16 v[224:239], v[44:47], v[48:51], v[224:239]
    v_mfma_f32_32x32x16_bf16 v[240:255], v[44:47], v[52:55], v[240:255]
    s_waitcnt lgkmcnt(0)
    s_waitcnt vmcnt(13)
    s_barrier
    v_mfma_f32_32x32x16_bf16 v[128:143], v[56:59], v[72:75], v[128:143]
    ds_read_b64_tr_b16 v[48:49], v20 offset:49152
    ds_read_b64_tr_b16 v[50:51], v20 offset:50176
    v_mfma_f32_32x32x16_bf16 v[144:159], v[56:59], v[76:79], v[144:159]
    s_add_u32 s91, s91, 131072
    s_and_b32 s91, s91, 0x1fffff
    s_add_u32 m0, s53, 40960
    ds_read_b64_tr_b16 v[52:53], v21 offset:49152
    ds_read_b64_tr_b16 v[54:55], v21 offset:50176
    buffer_load_dwordx4 v10, s[36:39], s91 offen sc1 lds
    v_mfma_f32_32x32x16_bf16 v[160:175], v[60:63], v[72:75], v[160:175]
    s_add_u32 m0, s53, 41984
    ds_read_b64_tr_b16 v[32:33], v16 offset:49152
    ds_read_b64_tr_b16 v[34:35], v16 offset:50176
    buffer_load_dwordx4 v15, s[36:39], s91 offen sc1 lds
    v_mfma_f32_32x32x16_bf16 v[176:191], v[60:63], v[76:79], v[176:191]
    ds_read_b64_tr_b16 v[36:37], v17 offset:49152
    ds_read_b64_tr_b16 v[38:39], v17 offset:50176
    v_mfma_f32_32x32x16_bf16 v[192:207], v[64:67], v[72:75], v[192:207]
    ds_read_b64_tr_b16 v[40:41], v18 offset:49152
    ds_read_b64_tr_b16 v[42:43], v18 offset:50176
    v_mfma_f32_32x32x16_bf16 v[208:223], v[64:67], v[76:79], v[208:223]
    ds_read_b64_tr_b16 v[44:45], v19 offset:49152
    ds_read_b64_tr_b16 v[46:47], v19 offset:50176
    v_mfma_f32_32x32x16_bf16 v[224:239], v[68:71], v[72:75], v[224:239]
    v_mfma_f32_32x32x16_bf16 v[240:255], v[68:71], v[76:79], v[240:255]
    s_waitcnt lgkmcnt(0)
    v_mfma_f32_32x32x16_bf16 v[128:143], v[32:35], v[48:51], v[128:143]
    ds_read_b64_tr_b16 v[72:73], v20 offset:53248
    ds_read_b64_tr_b16 v[74:75], v20 offset:54272
    v_mfma_f32_32x32x16_bf16 v[144:159], v[32:35], v[52:55], v[144:159]
    ds_read_b64_tr_b16 v[76:77], v21 offset:53248
    ds_read_b64_tr_b16 v[78:79], v21 offset:54272
    v_mfma_f32_32x32x16_bf16 v[160:175], v[36:39], v[48:51], v[160:175]
    ds_read_b64_tr_b16 v[56:57], v16 offset:53248
    ds_read_b64_tr_b16 v[58:59], v16 offset:54272
    v_mfma_f32_32x32x16_bf16 v[176:191], v[36:39], v[52:55], v[176:191]
    ds_read_b64_tr_b16 v[60:61], v17 offset:53248
    ds_read_b64_tr_b16 v[62:63], v17 offset:54272
    v_mfma_f32_32x32x16_bf16 v[192:207], v[40:43], v[48:51], v[192:207]
    ds_read_b64_tr_b16 v[64:65], v18 offset:53248
    ds_read_b64_tr_b16 v[66:67], v18 offset:54272
    v_mfma_f32_32x32x16_bf16 v[208:223], v[40:43], v[52:55], v[208:223]
    ds_read_b64_tr_b16 v[68:69], v19 offset:53248
    ds_read_b64_tr_b16 v[70:71], v19 offset:54272
    v_mfma_f32_32x32x16_bf16 v[224:239], v[44:47], v[48:51], v[224:239]
    v_mfma_f32_32x32x16_bf16 v[240:255], v[44:47], v[52:55], v[240:255]
    s_waitcnt lgkmcnt(0)
    s_waitcnt vmcnt(13)
    s_barrier
    v_mfma_f32_32x32x16_bf16 v[128:143], v[56:59], v[72:75], v[128:143]
    ds_read_b64_tr_b16 v[48:49], v26 offset:0
    ds_read_b64_tr_b16 v[50:51], v26 offset:1024
    v_mfma_f32_32x32x16_bf16 v[144:159], v[56:59], v[76:79], v[144:159]
    s_add_u32 s91, s91, 131072
    s_and_b32 s91, s91, 0x1fffff
    s_add_u32 m0, s53, 65536
    ds_read_b64_tr_b16 v[52:53], v27 offset:0
    ds_read_b64_tr_b16 v[54:55], v27 offset:1024
    buffer_load_dwordx4 v10, s[36:39], s91 offen sc1 lds
    v_mfma_f32_32x32x16_bf16 v[160:175], v[60:63], v[72:75], v[160:175]
    s_add_u32 m0, s53, 66560
    ds_read_b64_tr_b16 v[32:33], v22 offset:0
    ds_read_b64_tr_b16 v[34:35], v22 offset:1024
    buffer_load_dwordx4 v15, s[36:39], s91 offen sc1 lds
    v_mfma_f32_32x32x16_bf16 v[176:191], v[60:63], v[76:79], v[176:191]
    s_add_u32 s92, s88, 7
    s_and_b32 s92, s92, 15
    s_mul_i32 s92, s92, 114688
    s_add_u32 m0, s53, 24576
    ds_read_b64_tr_b16 v[36:37], v23 offset:0
    ds_read_b64_tr_b16 v[38:39], v23 offset:1024
    buffer_load_dwordx4 v8, s[28:31], s92 offen lds
    v_mfma_f32_32x32x16_bf16 v[192:207], v[64:67], v[72:75], v[192:207]
    s_add_u32 m0, s53, 32768
    ds_read_b64_tr_b16 v[40:41], v24 offset:0
    ds_read_b64_tr_b16 v[42:43], v24 offset:1024
    buffer_load_dwordx4 v9, s[32:35], s92 offen lds
    v_mfma_f32_32x32x16_bf16 v[208:223], v[64:67], v[76:79], v[208:223]
    ds_read_b64_tr_b16 v[44:45], v25 offset:0
    ds_read_b64_tr_b16 v[46:47], v25 offset:1024
    v_mfma_f32_32x32x16_bf16 v[224:239], v[68:71], v[72:75], v[224:239]
    v_mfma_f32_32x32x16_bf16 v[240:255], v[68:71], v[76:79], v[240:255]
    s_waitcnt lgkmcnt(0)
    s_waitcnt vmcnt(6)
    v_cmp_eq_u32 vcc, s98, v92
    v_cmp_eq_u32 s[48:49], s98, v93
    s_nop 3
    s_and_b64 vcc, vcc, s[48:49]
    v_cmp_eq_u32 s[48:49], s98, v94
    s_nop 3
    s_and_b64 vcc, vcc, s[48:49]
    v_cmp_eq_u32 s[48:49], s98, v95
    s_nop 3
    s_and_b64 vcc, vcc, s[48:49]
    s_cmp_eq_u64 vcc, exec
    s_cbranch_scc0 sequential_preLN__ssm_conv_s4d__geglu_ffn__prompt_kernel_slow4_17
sequential_preLN__ssm_conv_s4d__geglu_ffn__prompt_kernel_back4_18:
    s_add_u32 s60, s8, 0x7d0000
    s_addc_u32 s61, s9, 0
    s_mov_b32 s62, 0x8000
    s_mov_b32 s63, 0x20000
    v_mfma_f32_32x32x16_bf16 v[128:143], v[32:35], v[48:51], v[128:143]
    ds_read_b64_tr_b16 v[72:73], v26 offset:4096
    ds_read_b64_tr_b16 v[74:75], v26 offset:5120
    v_mfma_f32_32x32x16_bf16 v[144:159], v[32:35], v[52:55], v[144:159]
    s_add_u32 m0, s53, 25600
    ds_read_b64_tr_b16 v[76:77], v27 offset:4096
    ds_read_b64_tr_b16 v[78:79], v27 offset:5120
    buffer_load_dwordx4 v29, s[28:31], s92 offen lds
    v_mfma_f32_32x32x16_bf16 v[160:175], v[36:39], v[48:51], v[160:175]
    s_add_u32 m0, s53, 33792
    ds_read_b64_tr_b16 v[56:57], v22 offset:4096
    ds_read_b64_tr_b16 v[58:59], v22 offset:5120
    buffer_load_dwordx4 v30, s[32:35], s92 offen lds
    v_mfma_f32_32x32x16_bf16 v[176:191], v[36:39], v[52:55], v[176:191]
    ds_read_b64_tr_b16 v[60:61], v23 offset:4096
    ds_read_b64_tr_b16 v[62:63], v23 offset:5120
    buffer_load_dword v88, v6, s[40:43], 0 offen sc1
    v_mfma_f32_32x32x16_bf16 v[192:207], v[40:43], v[48:51], v[192:207]
    v_add_u32 v6, 14336, v6
    ds_read_b64_tr_b16 v[64:65], v24 offset:4096
    ds_read_b64_tr_b16 v[66:67], v24 offset:5120
    buffer_load_dword v89, v6, s[40:43], 0 offen sc1
    v_mfma_f32_32x32x16_bf16 v[208:223], v[40:43], v[52:55], v[208:223]
    v_add_u32 v6, 14336, v6
    ds_read_b64_tr_b16 v[68:69], v25 offset:4096
    ds_read_b64_tr_b16 v[70:71], v25 offset:5120
    buffer_load_dword v90, v6, s[40:43], 0 offen sc1
    v_mfma_f32_32x32x16_bf16 v[224:239], v[44:47], v[48:51], v[224:239]
    v_add_u32 v6, 14336, v6
    buffer_load_dword v91, v6, s[40:43], 0 offen sc1
    v_mfma_f32_32x32x16_bf16 v[240:255], v[44:47], v[52:55], v[240:255]
    s_waitcnt lgkmcnt(0)
    s_barrier
    v_mfma_f32_32x32x16_bf16 v[128:143], v[56:59], v[72:75], v[128:143]
    ds_read_b64_tr_b16 v[48:49], v26 offset:24576
    ds_read_b64_tr_b16 v[50:51], v26 offset:25600
    v_mfma_f32_32x32x16_bf16 v[144:159], v[56:59], v[76:79], v[144:159]
    s_add_u32 s91, s91, 131072
    s_and_b32 s91, s91, 0x1fffff
    s_add_u32 m0, s53, 90112
    ds_read_b64_tr_b16 v[52:53], v27 offset:24576
    ds_read_b64_tr_b16 v[54:55], v27 offset:25600
    buffer_load_dwordx4 v10, s[36:39], s91 offen sc1 lds
    v_mfma_f32_32x32x16_bf16 v[160:175], v[60:63], v[72:75], v[160:175]
    s_add_u32 m0, s53, 91136
    ds_read_b64_tr_b16 v[32:33], v22 offset:24576
    ds_read_b64_tr_b16 v[34:35], v22 offset:25600
    buffer_load_dwordx4 v15, s[36:39], s91 offen sc1 lds
    v_mfma_f32_32x32x16_bf16 v[176:191], v[60:63], v[76:79], v[176:191]
    s_add_u32 s92, s88, 8
    s_and_b32 s92, s92, 15
    s_mul_i32 s92, s92, 114688
    s_add_u32 m0, s53, 49152
    ds_read_b64_tr_b16 v[36:37], v23 offset:24576
    ds_read_b64_tr_b16 v[38:39], v23 offset:25600
    buffer_load_dwordx4 v8, s[28:31], s92 offen lds
    v_mfma_f32_32x32x16_bf16 v[192:207], v[64:67], v[72:75], v[192:207]
    s_add_u32 m0, s53, 57344
    ds_read_b64_tr_b16 v[40:41], v24 offset:24576
    ds_read_b64_tr_b16 v[42:43], v24 offset:25600
    buffer_load_dwordx4 v9, s[32:35], s92 offen lds
    v_mfma_f32_32x32x16_bf16 v[208:223], v[64:67], v[76:79], v[208:223]
    ds_read_b64_tr_b16 v[44:45], v25 offset:24576
    ds_read_b64_tr_b16 v[46:47], v25 offset:25600
    v_mfma_f32_32x32x16_bf16 v[224:239], v[68:71], v[72:75], v[224:239]
    v_mfma_f32_32x32x16_bf16 v[240:255], v[68:71], v[76:79], v[240:255]
    s_waitcnt lgkmcnt(0)
    v_mfma_f32_32x32x16_bf16 v[128:143], v[32:35], v[48:51], v[128:143]
    ds_read_b64_tr_b16 v[72:73], v26 offset:28672
    ds_read_b64_tr_b16 v[74:75], v26 offset:29696
    v_mfma_f32_32x32x16_bf16 v[144:159], v[32:35], v[52:55], v[144:159]
    s_add_u32 m0, s53, 50176
    ds_read_b64_tr_b16 v[76:77], v27 offset:28672
    ds_read_b64_tr_b16 v[78:79], v27 offset:29696
    buffer_load_dwordx4 v29, s[28:31], s92 offen lds
    v_mfma_f32_32x32x16_bf16 v[160:175], v[36:39], v[48:51], v[160:175]
    s_add_u32 m0, s53, 58368
    ds_read_b64_tr_b16 v[56:57], v22 offset:28672
    ds_read_b64_tr_b16 v[58:59], v22 offset:29696
    buffer_load_dwordx4 v30, s[32:35], s92 offen lds
    v_mfma_f32_32x32x16_bf16 v[176:191], v[36:39], v[52:55], v[176:191]
    ds_read_b64_tr_b16 v[60:61], v23 offset:28672
    ds_read_b64_tr_b16 v[62:63], v23 offset:29696
    v_mfma_f32_32x32x16_bf16 v[192:207], v[40:43], v[48:51], v[192:207]
    ds_read_b64_tr_b16 v[64:65], v24 offset:28672
    ds_read_b64_tr_b16 v[66:67], v24 offset:29696
    v_mfma_f32_32x32x16_bf16 v[208:223], v[40:43], v[52:55], v[208:223]
    ds_read_b64_tr_b16 v[68:69], v25 offset:28672
    ds_read_b64_tr_b16 v[70:71], v25 offset:29696
    v_mfma_f32_32x32x16_bf16 v[224:239], v[44:47], v[48:51], v[224:239]
    v_mfma_f32_32x32x16_bf16 v[240:255], v[44:47], v[52:55], v[240:255]
    s_waitcnt lgkmcnt(0)
    s_barrier
    v_mfma_f32_32x32x16_bf16 v[128:143], v[56:59], v[72:75], v[128:143]
    ds_read_b64_tr_b16 v[48:49], v26 offset:49152
    ds_read_b64_tr_b16 v[50:51], v26 offset:50176
    v_mfma_f32_32x32x16_bf16 v[144:159], v[56:59], v[76:79], v[144:159]
    s_add_u32 s91, s91, 131072
    s_and_b32 s91, s91, 0x1fffff
    s_add_u32 m0, s53, 114688
    ds_read_b64_tr_b16 v[52:53], v27 offset:49152
    ds_read_b64_tr_b16 v[54:55], v27 offset:50176
    buffer_load_dwordx4 v10, s[36:39], s91 offen sc1 lds
    v_mfma_f32_32x32x16_bf16 v[160:175], v[60:63], v[72:75], v[160:175]
    s_add_u32 m0, s53, 115712
    ds_read_b64_tr_b16 v[32:33], v22 offset:49152
    ds_read_b64_tr_b16 v[34:35], v22 offset:50176
    buffer_load_dwordx4 v15, s[36:39], s91 offen sc1 lds
    v_mfma_f32_32x32x16_bf16 v[176:191], v[60:63], v[76:79], v[176:191]
    s_add_u32 s92, s88, 9
    s_and_b32 s92, s92, 15
    s_mul_i32 s92, s92, 114688
    s_add_u32 m0, s53, 73728
    ds_read_b64_tr_b16 v[36:37], v23 offset:49152
    ds_read_b64_tr_b16 v[38:39], v23 offset:50176
    buffer_load_dwordx4 v8, s[28:31], s92 offen lds
    v_mfma_f32_32x32x16_bf16 v[192:207], v[64:67], v[72:75], v[192:207]
    s_add_u32 m0, s53, 81920
    ds_read_b64_tr_b16 v[40:41], v24 offset:49152
    ds_read_b64_tr_b16 v[42:43], v24 offset:50176
    buffer_load_dwordx4 v9, s[32:35], s92 offen lds
    v_mfma_f32_32x32x16_bf16 v[208:223], v[64:67], v[76:79], v[208:223]
    ds_read_b64_tr_b16 v[44:45], v25 offset:49152
    ds_read_b64_tr_b16 v[46:47], v25 offset:50176
    v_mfma_f32_32x32x16_bf16 v[224:239], v[68:71], v[72:75], v[224:239]
    v_mfma_f32_32x32x16_bf16 v[240:255], v[68:71], v[76:79], v[240:255]
    s_waitcnt lgkmcnt(0)
    v_mfma_f32_32x32x16_bf16 v[128:143], v[32:35], v[48:51], v[128:143]
    ds_read_b64_tr_b16 v[72:73], v26 offset:53248
    ds_read_b64_tr_b16 v[74:75], v26 offset:54272
    v_mfma_f32_32x32x16_bf16 v[144:159], v[32:35], v[52:55], v[144:159]
    s_add_u32 m0, s53, 74752
    ds_read_b64_tr_b16 v[76:77], v27 offset:53248
    ds_read_b64_tr_b16 v[78:79], v27 offset:54272
    buffer_load_dwordx4 v29, s[28:31], s92 offen lds
    v_mfma_f32_32x32x16_bf16 v[160:175], v[36:39], v[48:51], v[160:175]
    s_add_u32 m0, s53, 82944
    ds_read_b64_tr_b16 v[56:57], v22 offset:53248
    ds_read_b64_tr_b16 v[58:59], v22 offset:54272
    buffer_load_dwordx4 v30, s[32:35], s92 offen lds
    v_mfma_f32_32x32x16_bf16 v[176:191], v[36:39], v[52:55], v[176:191]
    ds_read_b64_tr_b16 v[60:61], v23 offset:53248
    ds_read_b64_tr_b16 v[62:63], v23 offset:54272
    v_mfma_f32_32x32x16_bf16 v[192:207], v[40:43], v[48:51], v[192:207]
    ds_read_b64_tr_b16 v[64:65], v24 offset:53248
    ds_read_b64_tr_b16 v[66:67], v24 offset:54272
    v_mfma_f32_32x32x16_bf16 v[208:223], v[40:43], v[52:55], v[208:223]
    ds_read_b64_tr_b16 v[68:69], v25 offset:53248
    ds_read_b64_tr_b16 v[70:71], v25 offset:54272
    v_mfma_f32_32x32x16_bf16 v[224:239], v[44:47], v[48:51], v[224:239]
    v_mfma_f32_32x32x16_bf16 v[240:255], v[44:47], v[52:55], v[240:255]
    s_waitcnt lgkmcnt(0)
    s_barrier
    v_mfma_f32_32x32x16_bf16 v[128:143], v[56:59], v[72:75], v[128:143]
    ds_read_b64_tr_b16 v[48:49], v20 offset:0
    ds_read_b64_tr_b16 v[50:51], v20 offset:1024
    v_mfma_f32_32x32x16_bf16 v[144:159], v[56:59], v[76:79], v[144:159]
    s_add_u32 s91, s91, 131072
    s_and_b32 s91, s91, 0x1fffff
    s_add_u32 m0, s53, 139264
    ds_read_b64_tr_b16 v[52:53], v21 offset:0
    ds_read_b64_tr_b16 v[54:55], v21 offset:1024
    buffer_load_dwordx4 v10, s[36:39], s91 offen sc1 lds
    v_mfma_f32_32x32x16_bf16 v[160:175], v[60:63], v[72:75], v[160:175]
    s_add_u32 m0, s53, 140288
    ds_read_b64_tr_b16 v[32:33], v16 offset:0
    ds_read_b64_tr_b16 v[34:35], v16 offset:1024
    buffer_load_dwordx4 v15, s[36:39], s91 offen sc1 lds
    v_mfma_f32_32x32x16_bf16 v[176:191], v[60:63], v[76:79], v[176:191]
    s_add_u32 s92, s88, 10
    s_and_b32 s92, s92, 15
    s_mul_i32 s92, s92, 114688
    s_add_u32 m0, s53, 98304
    ds_read_b64_tr_b16 v[36:37], v17 offset:0
    ds_read_b64_tr_b16 v[38:39], v17 offset:1024
    buffer_load_dwordx4 v8, s[28:31], s92 offen lds
    v_mfma_f32_32x32x16_bf16 v[192:207], v[64:67], v[72:75], v[192:207]
    s_add_u32 m0, s53, 106496
    ds_read_b64_tr_b16 v[40:41], v18 offset:0
    ds_read_b64_tr_b16 v[42:43], v18 offset:1024
    buffer_load_dwordx4 v9, s[32:35], s92 offen lds
    v_mfma_f32_32x32x16_bf16 v[208:223], v[64:67], v[76:79], v[208:223]
    ds_read_b64_tr_b16 v[44:45], v19 offset:0
    ds_read_b64_tr_b16 v[46:47], v19 offset:1024
    v_mfma_f32_32x32x16_bf16 v[224:239], v[68:71], v[72:75], v[224:239]
    v_mfma_f32_32x32x16_bf16 v[240:255], v[68:71], v[76:79], v[240:255]
    s_waitcnt lgkmcnt(0)
    s_waitcnt vmcnt(16)
    v_lshlrev_b32 v2, 2, v0
    v_add_u32 v2, 147456, v2
    v_add_f32 v88, v88, v89
    v_add_f32 v90, v90, v91
    v_add_f32 v88, v88, v90
    ds_write_b32 v2, v88
    v_mfma_f32_32x32x16_bf16 v[128:143], v[32:35], v[48:51], v[128:143]
    ds_read_b64_tr_b16 v[72:73], v20 offset:4096
    ds_read_b64_tr_b16 v[74:75], v20 offset:5120
    v_mfma_f32_32x32x16_bf16 v[144:159], v[32:35], v[52:55], v[144:159]
    s_add_u32 m0, s53, 99328
    ds_read_b64_tr_b16 v[76:77], v21 offset:4096
    ds_read_b64_tr_b16 v[78:79], v21 offset:5120
    buffer_load_dwordx4 v29, s[28:31], s92 offen lds
    v_mfma_f32_32x32x16_bf16 v[160:175], v[36:39], v[48:51], v[160:175]
    s_add_u32 m0, s53, 107520
    ds_read_b64_tr_b16 v[56:57], v16 offset:4096
    ds_read_b64_tr_b16 v[58:59], v16 offset:5120
    buffer_load_dwordx4 v30, s[32:35], s92 offen lds
    v_mfma_f32_32x32x16_bf16 v[176:191], v[36:39], v[52:55], v[176:191]
    ds_read_b64_tr_b16 v[60:61], v17 offset:4096
    ds_read_b64_tr_b16 v[62:63], v17 offset:5120
    v_mfma_f32_32x32x16_bf16 v[192:207], v[40:43], v[48:51], v[192:207]
    ds_read_b64_tr_b16 v[64:65], v18 offset:4096
    ds_read_b64_tr_b16 v[66:67], v18 offset:5120
    v_mfma_f32_32x32x16_bf16 v[208:223], v[40:43], v[52:55], v[208:223]
    ds_read_b64_tr_b16 v[68:69], v19 offset:4096
    ds_read_b64_tr_b16 v[70:71], v19 offset:5120
    v_mfma_f32_32x32x16_bf16 v[224:239], v[44:47], v[48:51], v[224:239]
    v_mfma_f32_32x32x16_bf16 v[240:255], v[44:47], v[52:55], v[240:255]
    s_waitcnt lgkmcnt(0)
    s_barrier
    v_mfma_f32_32x32x16_bf16 v[128:143], v[56:59], v[72:75], v[128:143]
    ds_read_b64_tr_b16 v[48:49], v20 offset:24576
    ds_read_b64_tr_b16 v[50:51], v20 offset:25600
    v_mfma_f32_32x32x16_bf16 v[144:159], v[56:59], v[76:79], v[144:159]
    s_add_u32 s91, s91, 131072
    s_and_b32 s91, s91, 0x1fffff
    s_add_u32 m0, s53, 16384
    ds_read_b64_tr_b16 v[52:53], v21 offset:24576
    ds_read_b64_tr_b16 v[54:55], v21 offset:25600
    buffer_load_dwordx4 v10, s[36:39], s91 offen sc1 lds
    v_mfma_f32_32x32x16_bf16 v[160:175], v[60:63], v[72:75], v[160:175]
    s_add_u32 m0, s53, 17408
    ds_read_b64_tr_b16 v[32:33], v16 offset:24576
    ds_read_b64_tr_b16 v[34:35], v16 offset:25600
    buffer_load_dwordx4 v15, s[36:39], s91 offen sc1 lds
    v_mfma_f32_32x32x16_bf16 v[176:191], v[60:63], v[76:79], v[176:191]
    s_add_u32 s92, s88, 11
    s_and_b32 s92, s92, 15
    s_mul_i32 s92, s92, 114688
    s_add_u32 m0, s53, 122880
    ds_read_b64_tr_b16 v[36:37], v17 offset:24576
    ds_read_b64_tr_b16 v[38:39], v17 offset:25600
    buffer_load_dwordx4 v8, s[28:31], s92 offen lds
    v_mfma_f32_32x32x16_bf16 v[192:207], v[64:67], v[72:75], v[192:207]
    s_add_u32 m0, s53, 131072
    ds_read_b64_tr_b16 v[40:41], v18 offset:24576
    ds_read_b64_tr_b16 v[42:43], v18 offset:25600
    buffer_load_dwordx4 v9, s[32:35], s92 offen lds
    v_mfma_f32_32x32x16_bf16 v[208:223], v[64:67], v[76:79], v[208:223]
    ds_read_b64_tr_b16 v[44:45], v19 offset:24576
    ds_read_b64_tr_b16 v[46:47], v19 offset:25600
    v_mfma_f32_32x32x16_bf16 v[224:239], v[68:71], v[72:75], v[224:239]
    v_mfma_f32_32x32x16_bf16 v[240:255], v[68:71], v[76:79], v[240:255]
    s_waitcnt lgkmcnt(0)
    v_mfma_f32_32x32x16_bf16 v[128:143], v[32:35], v[48:51], v[128:143]
    ds_read_b64_tr_b16 v[72:73], v20 offset:28672
    ds_read_b64_tr_b16 v[74:75], v20 offset:29696
    v_mfma_f32_32x32x16_bf16 v[144:159], v[32:35], v[52:55], v[144:159]
    s_add_u32 m0, s53, 123904
    ds_read_b64_tr_b16 v[76:77], v21 offset:28672
    ds_read_b64_tr_b16 v[78:79], v21 offset:29696
    buffer_load_dwordx4 v29, s[28:31], s92 offen lds
    v_mfma_f32_32x32x16_bf16 v[160:175], v[36:39], v[48:51], v[160:175]
    s_add_u32 m0, s53, 132096
    ds_read_b64_tr_b16 v[56:57], v16 offset:28672
    ds_read_b64_tr_b16 v[58:59], v16 offset:29696
    buffer_load_dwordx4 v30, s[32:35], s92 offen lds
    v_mfma_f32_32x32x16_bf16 v[176:191], v[36:39], v[52:55], v[176:191]
    ds_read_b64_tr_b16 v[60:61], v17 offset:28672
    ds_read_b64_tr_b16 v[62:63], v17 offset:29696
    v_mfma_f32_32x32x16_bf16 v[192:207], v[40:43], v[48:51], v[192:207]
    ds_read_b64_tr_b16 v[64:65], v18 offset:28672
    ds_read_b64_tr_b16 v[66:67], v18 offset:29696
    v_mfma_f32_32x32x16_bf16 v[208:223], v[40:43], v[52:55], v[208:223]
    ds_read_b64_tr_b16 v[68:69], v19 offset:28672
    ds_read_b64_tr_b16 v[70:71], v19 offset:29696
    v_mfma_f32_32x32x16_bf16 v[224:239], v[44:47], v[48:51], v[224:239]
    v_mfma_f32_32x32x16_bf16 v[240:255], v[44:47], v[52:55], v[240:255]
    s_waitcnt lgkmcnt(0)
    s_waitcnt vmcnt(18)
    s_barrier
    v_mfma_f32_32x32x16_bf16 v[128:143], v[56:59], v[72:75], v[128:143]
    ds_read_b64_tr_b16 v[48:49], v20 offset:49152
    ds_read_b64_tr_b16 v[50:51], v20 offset:50176
    v_mfma_f32_32x32x16_bf16 v[144:159], v[56:59], v[76:79], v[144:159]
    s_add_u32 s91, s91, 131072
    s_and_b32 s91, s91, 0x1fffff
    s_add_u32 m0, s53, 40960
    ds_read_b64_tr_b16 v[52:53], v21 offset:49152
    ds_read_b64_tr_b16 v[54:55], v21 offset:50176
    buffer_load_dwordx4 v10, s[36:39], s91 offen sc1 lds
    v_mfma_f32_32x32x16_bf16 v[160:175], v[60:63], v[72:75], v[160:175]
    s_add_u32 m0, s53, 41984
    ds_read_b64_tr_b16 v[32:33], v16 offset:49152
    ds_read_b64_tr_b16 v[34:35], v16 offset:50176
    buffer_load_dwordx4 v15, s[36:39], s91 offen sc1 lds
    v_mfma_f32_32x32x16_bf16 v[176:191], v[60:63], v[76:79], v[176:191]
    s_add_u32 s92, s88, 12
    s_and_b32 s92, s92, 15
    s_mul_i32 s92, s92, 114688
    s_add_u32 m0, s53, 0
    ds_read_b64_tr_b16 v[36:37], v17 offset:49152
    ds_read_b64_tr_b16 v[38:39], v17 offset:50176
    buffer_load_dwordx4 v8, s[28:31], s92 offen lds
    v_mfma_f32_32x32x16_bf16 v[192:207], v[64:67], v[72:75], v[192:207]
    s_add_u32 m0, s53, 8192
    ds_read_b64_tr_b16 v[40:41], v18 offset:49152
    ds_read_b64_tr_b16 v[42:43], v18 offset:50176
    buffer_load_dwordx4 v9, s[32:35], s92 offen lds
    v_mfma_f32_32x32x16_bf16 v[208:223], v[64:67], v[76:79], v[208:223]
    ds_read_b64_tr_b16 v[44:45], v19 offset:49152
    ds_read_b64_tr_b16 v[46:47], v19 offset:50176
    v_mfma_f32_32x32x16_bf16 v[224:239], v[68:71], v[72:75], v[224:239]
    v_mfma_f32_32x32x16_bf16 v[240:255], v[68:71], v[76:79], v[240:255]
    s_waitcnt lgkmcnt(0)
    v_mfma_f32_32x32x16_bf16 v[128:143], v[32:35], v[48:51], v[128:143]
    ds_read_b64_tr_b16 v[72:73], v20 offset:53248
    ds_read_b64_tr_b16 v[74:75], v20 offset:54272
    v_mfma_f32_32x32x16_bf16 v[144:159], v[32:35], v[52:55], v[144:159]
    s_add_u32 m0, s53, 1024
    ds_read_b64_tr_b16 v[76:77], v21 offset:53248
    ds_read_b64_tr_b16 v[78:79], v21 offset:54272
    buffer_load_dwordx4 v29, s[28:31], s92 offen lds
    v_mfma_f32_32x32x16_bf16 v[160:175], v[36:39], v[48:51], v[160:175]
    s_add_u32 m0, s53, 9216
    ds_read_b64_tr_b16 v[56:57], v16 offset:53248
    ds_read_b64_tr_b16 v[58:59], v16 offset:54272
    buffer_load_dwordx4 v30, s[32:35], s92 offen lds
    v_mfma_f32_32x32x16_bf16 v[176:191], v[36:39], v[52:55], v[176:191]
    ds_read_b64_tr_b16 v[60:61], v17 offset:53248
    ds_read_b64_tr_b16 v[62:63], v17 offset:54272
    v_mfma_f32_32x32x16_bf16 v[192:207], v[40:43], v[48:51], v[192:207]
    ds_read_b64_tr_b16 v[64:65], v18 offset:53248
    ds_read_b64_tr_b16 v[66:67], v18 offset:54272
    v_mfma_f32_32x32x16_bf16 v[208:223], v[40:43], v[52:55], v[208:223]
    ds_read_b64_tr_b16 v[68:69], v19 offset:53248
    ds_read_b64_tr_b16 v[70:71], v19 offset:54272
    v_mfma_f32_32x32x16_bf16 v[224:239], v[44:47], v[48:51], v[224:239]
    v_mfma_f32_32x32x16_bf16 v[240:255], v[44:47], v[52:55], v[240:255]
    s_waitcnt lgkmcnt(0)
    s_waitcnt vmcnt(18)
    s_barrier
    v_mfma_f32_32x32x16_bf16 v[128:143], v[56:59], v[72:75], v[128:143]
    ds_read_b64_tr_b16 v[48:49], v26 offset:0
    ds_read_b64_tr_b16 v[50:51], v26 offset:1024
    v_mfma_f32_32x32x16_bf16 v[144:159], v[56:59], v[76:79], v[144:159]
    s_add_u32 s91, s91, 131072
    s_and_b32 s91, s91, 0x1fffff
    s_add_u32 m0, s53, 65536
    ds_read_b64_tr_b16 v[52:53], v27 offset:0
    ds_read_b64_tr_b16 v[54:55], v27 offset:1024
    buffer_load_dwordx4 v10, s[36:39], s91 offen sc1 lds
    v_mfma_f32_32x32x16_bf16 v[160:175], v[60:63], v[72:75], v[160:175]
    s_add_u32 m0, s53, 66560
    ds_read_b64_tr_b16 v[32:33], v22 offset:0
    ds_read_b64_tr_b16 v[34:35], v22 offset:1024
    buffer_load_dwordx4 v15, s[36:39], s91 offen sc1 lds
    v_mfma_f32_32x32x16_bf16 v[176:191], v[60:63], v[76:79], v[176:191]
    s_add_u32 s92, s88, 13
    s_and_b32 s92, s92, 15
    s_mul_i32 s92, s92, 114688
    s_add_u32 m0, s53, 24576
    ds_read_b64_tr_b16 v[36:37], v23 offset:0
    ds_read_b64_tr_b16 v[38:39], v23 offset:1024
    buffer_load_dwordx4 v8, s[28:31], s92 offen lds
    v_mfma_f32_32x32x16_bf16 v[192:207], v[64:67], v[72:75], v[192:207]
    s_add_u32 m0, s53, 32768
    ds_read_b64_tr_b16 v[40:41], v24 offset:0
    ds_read_b64_tr_b16 v[42:43], v24 offset:1024
    buffer_load_dwordx4 v9, s[32:35], s92 offen lds
    v_mfma_f32_32x32x16_bf16 v[208:223], v[64:67], v[76:79], v[208:223]
    ds_read_b64_tr_b16 v[44:45], v25 offset:0
    ds_read_b64_tr_b16 v[46:47], v25 offset:1024
    v_mfma_f32_32x32x16_bf16 v[224:239], v[68:71], v[72:75], v[224:239]
    v_mfma_f32_32x32x16_bf16 v[240:255], v[68:71], v[76:79], v[240:255]
    s_waitcnt lgkmcnt(0)
    v_mfma_f32_32x32x16_bf16 v[128:143], v[32:35], v[48:51], v[128:143]
    ds_read_b64_tr_b16 v[72:73], v26 offset:4096
    ds_read_b64_tr_b16 v[74:75], v26 offset:5120
    v_mfma_f32_32x32x16_bf16 v[144:159], v[32:35], v[52:55], v[144:159]
    s_add_u32 m0, s53, 25600
    ds_read_b64_tr_b16 v[76:77], v27 offset:4096
    ds_read_b64_tr_b16 v[78:79], v27 offset:5120
    buffer_load_dwordx4 v29, s[28:31], s92 offen lds
    v_mfma_f32_32x32x16_bf16 v[160:175], v[36:39], v[48:51], v[160:175]
    s_add_u32 m0, s53, 33792
    ds_read_b64_tr_b16 v[56:57], v22 offset:4096
    ds_read_b64_tr_b16 v[58:59], v22 offset:5120
    buffer_load_dwordx4 v30, s[32:35], s92 offen lds
    v_mfma_f32_32x32x16_bf16 v[176:191], v[36:39], v[52:55], v[176:191]
    ds_read_b64_tr_b16 v[60:61], v23 offset:4096
    ds_read_b64_tr_b16 v[62:63], v23 offset:5120
    v_mfma_f32_32x32x16_bf16 v[192:207], v[40:43], v[48:51], v[192:207]
    ds_read_b64_tr_b16 v[64:65], v24 offset:4096
    ds_read_b64_tr_b16 v[66:67], v24 offset:5120
    v_mfma_f32_32x32x16_bf16 v[208:223], v[40:43], v[52:55], v[208:223]
    ds_read_b64_tr_b16 v[68:69], v25 offset:4096
    ds_read_b64_tr_b16 v[70:71], v25 offset:5120
    v_mfma_f32_32x32x16_bf16 v[224:239], v[44:47], v[48:51], v[224:239]
    v_mfma_f32_32x32x16_bf16 v[240:255], v[44:47], v[52:55], v[240:255]
    s_waitcnt lgkmcnt(0)
    s_waitcnt vmcnt(18)
    s_barrier
    v_mfma_f32_32x32x16_bf16 v[128:143], v[56:59], v[72:75], v[128:143]
    ds_read_b64_tr_b16 v[48:49], v26 offset:24576
    ds_read_b64_tr_b16 v[50:51], v26 offset:25600
    v_mfma_f32_32x32x16_bf16 v[144:159], v[56:59], v[76:79], v[144:159]
    s_add_u32 s91, s91, 131072
    s_and_b32 s91, s91, 0x1fffff
    s_add_u32 m0, s53, 90112
    ds_read_b64_tr_b16 v[52:53], v27 offset:24576
    ds_read_b64_tr_b16 v[54:55], v27 offset:25600
    buffer_load_dwordx4 v10, s[36:39], s91 offen sc1 lds
    v_mfma_f32_32x32x16_bf16 v[160:175], v[60:63], v[72:75], v[160:175]
    s_add_u32 m0, s53, 91136
    ds_read_b64_tr_b16 v[32:33], v22 offset:24576
    ds_read_b64_tr_b16 v[34:35], v22 offset:25600
    buffer_load_dwordx4 v15, s[36:39], s91 offen sc1 lds
    v_mfma_f32_32x32x16_bf16 v[176:191], v[60:63], v[76:79], v[176:191]
    s_add_u32 s92, s88, 14
    s_and_b32 s92, s92, 15
    s_mul_i32 s92, s92, 114688
    s_add_u32 m0, s53, 49152
    ds_read_b64_tr_b16 v[36:37], v23 offset:24576
    ds_read_b64_tr_b16 v[38:39], v23 offset:25600
    buffer_load_dwordx4 v8, s[28:31], s92 offen lds
    v_mfma_f32_32x32x16_bf16 v[192:207], v[64:67], v[72:75], v[192:207]
    s_add_u32 m0, s53, 57344
    ds_read_b64_tr_b16 v[40:41], v24 offset:24576
    ds_read_b64_tr_b16 v[42:43], v24 offset:25600
    buffer_load_dwordx4 v9, s[32:35], s92 offen lds
    v_mfma_f32_32x32x16_bf16 v[208:223], v[64:67], v[76:79], v[208:223]
    ds_read_b64_tr_b16 v[44:45], v25 offset:24576
    ds_read_b64_tr_b16 v[46:47], v25 offset:25600
    v_mfma_f32_32x32x16_bf16 v[224:239], v[68:71], v[72:75], v[224:239]
    v_mfma_f32_32x32x16_bf16 v[240:255], v[68:71], v[76:79], v[240:255]
    s_waitcnt lgkmcnt(0)
    v_mfma_f32_32x32x16_bf16 v[128:143], v[32:35], v[48:51], v[128:143]
    ds_read_b64_tr_b16 v[72:73], v26 offset:28672
    ds_read_b64_tr_b16 v[74:75], v26 offset:29696
    v_mfma_f32_32x32x16_bf16 v[144:159], v[32:35], v[52:55], v[144:159]
    s_add_u32 m0, s53, 50176
    ds_read_b64_tr_b16 v[76:77], v27 offset:28672
    ds_read_b64_tr_b16 v[78:79], v27 offset:29696
    buffer_load_dwordx4 v29, s[28:31], s92 offen lds
    v_mfma_f32_32x32x16_bf16 v[160:175], v[36:39], v[48:51], v[160:175]
    s_add_u32 m0, s53, 58368
    ds_read_b64_tr_b16 v[56:57], v22 offset:28672
    ds_read_b64_tr_b16 v[58:59], v22 offset:29696
    buffer_load_dwordx4 v30, s[32:35], s92 offen lds
    v_mfma_f32_32x32x16_bf16 v[176:191], v[36:39], v[52:55], v[176:191]
    s_add_u32 s92, s88, 15
    s_and_b32 s92, s92, 15
    s_mul_i32 s92, s92, 114688
    s_add_u32 m0, s53, 73728
    ds_read_b64_tr_b16 v[60:61], v23 offset:28672
    ds_read_b64_tr_b16 v[62:63], v23 offset:29696
    buffer_load_dwordx4 v8, s[28:31], s92 offen lds
    v_mfma_f32_32x32x16_bf16 v[192:207], v[40:43], v[48:51], v[192:207]
    s_add_u32 m0, s53, 81920
    ds_read_b64_tr_b16 v[64:65], v24 offset:28672
    ds_read_b64_tr_b16 v[66:67], v24 offset:29696
    buffer_load_dwordx4 v9, s[32:35], s92 offen lds
    v_mfma_f32_32x32x16_bf16 v[208:223], v[40:43], v[52:55], v[208:223]
    ds_read_b64_tr_b16 v[68:69], v25 offset:28672
    ds_read_b64_tr_b16 v[70:71], v25 offset:29696
    buffer_load_dword v28, v4, s[64:67], s51 offen sc1
    v_mfma_f32_32x32x16_bf16 v[224:239], v[44:47], v[48:51], v[224:239]
    v_mfma_f32_32x32x16_bf16 v[240:255], v[44:47], v[52:55], v[240:255]
    s_waitcnt lgkmcnt(0)
    s_waitcnt vmcnt(21)
    s_barrier
    v_mfma_f32_32x32x16_bf16 v[128:143], v[56:59], v[72:75], v[128:143]
    ds_read_b64_tr_b16 v[48:49], v26 offset:49152
    ds_read_b64_tr_b16 v[50:51], v26 offset:50176
    v_mfma_f32_32x32x16_bf16 v[144:159], v[56:59], v[76:79], v[144:159]
    s_add_u32 m0, s53, 74752
    ds_read_b64_tr_b16 v[52:53], v27 offset:49152
    ds_read_b64_tr_b16 v[54:55], v27 offset:50176
    buffer_load_dwordx4 v29, s[28:31], s92 offen lds
    v_mfma_f32_32x32x16_bf16 v[160:175], v[60:63], v[72:75], v[160:175]
    s_add_u32 m0, s53, 82944
    ds_read_b64_tr_b16 v[32:33], v22 offset:49152
    ds_read_b64_tr_b16 v[34:35], v22 offset:50176
    buffer_load_dwordx4 v30, s[32:35], s92 offen lds
    v_mfma_f32_32x32x16_bf16 v[176:191], v[60:63], v[76:79], v[176:191]
    ds_read_b64_tr_b16 v[36:37], v23 offset:49152
    ds_read_b64_tr_b16 v[38:39], v23 offset:50176
    v_mfma_f32_32x32x16_bf16 v[192:207], v[64:67], v[72:75], v[192:207]
    ds_read_b64_tr_b16 v[40:41], v24 offset:49152
    ds_read_b64_tr_b16 v[42:43], v24 offset:50176
    v_mfma_f32_32x32x16_bf16 v[208:223], v[64:67], v[76:79], v[208:223]
    ds_read_b64_tr_b16 v[44:45], v25 offset:49152
    ds_read_b64_tr_b16 v[46:47], v25 offset:50176
    v_mfma_f32_32x32x16_bf16 v[224:239], v[68:71], v[72:75], v[224:239]
    v_mfma_f32_32x32x16_bf16 v[240:255], v[68:71], v[76:79], v[240:255]
    s_waitcnt lgkmcnt(0)
    v_mfma_f32_32x32x16_bf16 v[128:143], v[32:35], v[48:51], v[128:143]
    ds_read_b64_tr_b16 v[72:73], v26 offset:53248
    ds_read_b64_tr_b16 v[74:75], v26 offset:54272
    v_mfma_f32_32x32x16_bf16 v[144:159], v[32:35], v[52:55], v[144:159]
    ds_read_b64_tr_b16 v[76:77], v27 offset:53248
    ds_read_b64_tr_b16 v[78:79], v27 offset:54272
    buffer_load_dwordx4 a[0:3], v3, s[56:59], s14 offen offset:0 sc1
    v_mfma_f32_32x32x16_bf16 v[160:175], v[36:39], v[48:51], v[160:175]
    ds_read_b64_tr_b16 v[56:57], v22 offset:53248
    ds_read_b64_tr_b16 v[58:59], v22 offset:54272
    buffer_load_dwordx4 a[4:7], v3, s[56:59], s15 offen offset:0 sc1
    v_mfma_f32_32x32x16_bf16 v[176:191], v[36:39], v[52:55], v[176:191]
    ds_read_b64_tr_b16 v[60:61], v23 offset:53248
    ds_read_b64_tr_b16 v[62:63], v23 offset:54272
    buffer_load_dwordx4 a[8:11], v3, s[56:59], s14 offen offset:1024 sc1
    v_mfma_f32_32x32x16_bf16 v[192:207], v[40:43], v[48:51], v[192:207]
    ds_read_b64_tr_b16 v[64:65], v24 offset:53248
    ds_read_b64_tr_b16 v[66:67], v24 offset:54272
    buffer_load_dwordx4 a[12:15], v3, s[56:59], s15 offen offset:1024 sc1
    v_mfma_f32_32x32x16_bf16 v[208:223], v[40:43], v[52:55], v[208:223]
    ds_read_b64_tr_b16 v[68:69], v25 offset:53248
    ds_read_b64_tr_b16 v[70:71], v25 offset:54272
    v_mfma_f32_32x32x16_bf16 v[224:239], v[44:47], v[48:51], v[224:239]
    v_mfma_f32_32x32x16_bf16 v[240:255], v[44:47], v[52:55], v[240:255]
    s_waitcnt lgkmcnt(0)
    s_waitcnt vmcnt(21)
    s_barrier
    v_mfma_f32_32x32x16_bf16 v[128:143], v[56:59], v[72:75], v[128:143]
    ds_read_b64_tr_b16 v[48:49], v20 offset:0
    ds_read_b64_tr_b16 v[50:51], v20 offset:1024
    v_mfma_f32_32x32x16_bf16 v[144:159], v[56:59], v[76:79], v[144:159]
    ds_read_b64_tr_b16 v[52:53], v21 offset:0
    ds_read_b64_tr_b16 v[54:55], v21 offset:1024
    buffer_load_dwordx4 a[16:19], v3, s[56:59], s14 offen offset:2048 sc1
    v_mfma_f32_32x32x16_bf16 v[160:175], v[60:63], v[72:75], v[160:175]
    ds_read_b64_tr_b16 v[32:33], v16 offset:0
    ds_read_b64_tr_b16 v[34:35], v16 offset:1024
    buffer_load_dwordx4 a[20:23], v3, s[56:59], s15 offen offset:2048 sc1
    v_mfma_f32_32x32x16_bf16 v[176:191], v[60:63], v[76:79], v[176:191]
    ds_read_b64_tr_b16 v[36:37], v17 offset:0
    ds_read_b64_tr_b16 v[38:39], v17 offset:1024
    buffer_load_dwordx4 a[24:27], v3, s[56:59], s14 offen offset:3072 sc1
    v_mfma_f32_32x32x16_bf16 v[192:207], v[64:67], v[72:75], v[192:207]
    ds_read_b64_tr_b16 v[40:41], v18 offset:0
    ds_read_b64_tr_b16 v[42:43], v18 offset:1024
    buffer_load_dwordx4 a[28:31], v3, s[56:59], s15 offen offset:3072 sc1
    v_mfma_f32_32x32x16_bf16 v[208:223], v[64:67], v[76:79], v[208:223]
    ds_read_b64_tr_b16 v[44:45], v19 offset:0
    ds_read_b64_tr_b16 v[46:47], v19 offset:1024
    v_mfma_f32_32x32x16_bf16 v[224:239], v[68:71], v[72:75], v[224:239]
    v_mfma_f32_32x32x16_bf16 v[240:255], v[68:71], v[76:79], v[240:255]
    s_waitcnt lgkmcnt(0)
    v_mfma_f32_32x32x16_bf16 v[128:143], v[32:35], v[48:51], v[128:143]
    ds_read_b64_tr_b16 v[72:73], v20 offset:4096
    ds_read_b64_tr_b16 v[74:75], v20 offset:5120
    v_mfma_f32_32x32x16_bf16 v[144:159], v[32:35], v[52:55], v[144:159]
    s_add_u32 s14, s14, 4096
    s_add_u32 s15, s15, 4096
    ds_read_b64_tr_b16 v[76:77], v21 offset:4096
    ds_read_b64_tr_b16 v[78:79], v21 offset:5120
    buffer_load_dwordx4 a[32:35], v3, s[56:59], s14 offen offset:0 sc1
    v_mfma_f32_32x32x16_bf16 v[160:175], v[36:39], v[48:51], v[160:175]
    ds_read_b64_tr_b16 v[56:57], v16 offset:4096
    ds_read_b64_tr_b16 v[58:59], v16 offset:5120
    buffer_load_dwordx4 a[36:39], v3, s[56:59], s15 offen offset:0 sc1
    v_mfma_f32_32x32x16_bf16 v[176:191], v[36:39], v[52:55], v[176:191]
    ds_read_b64_tr_b16 v[60:61], v17 offset:4096
    ds_read_b64_tr_b16 v[62:63], v17 offset:5120
    buffer_load_dwordx4 a[40:43], v3, s[56:59], s14 offen offset:1024 sc1
    v_mfma_f32_32x32x16_bf16 v[192:207], v[40:43], v[48:51], v[192:207]
    ds_read_b64_tr_b16 v[64:65], v18 offset:4096
    ds_read_b64_tr_b16 v[66:67], v18 offset:5120
    buffer_load_dwordx4 a[44:47], v3, s[56:59], s15 offen offset:1024 sc1
    v_mfma_f32_32x32x16_bf16 v[208:223], v[40:43], v[52:55], v[208:223]
    ds_read_b64_tr_b16 v[68:69], v19 offset:4096
    ds_read_b64_tr_b16 v[70:71], v19 offset:5120
    v_mfma_f32_32x32x16_bf16 v[224:239], v[44:47], v[48:51], v[224:239]
    v_mfma_f32_32x32x16_bf16 v[240:255], v[44:47], v[52:55], v[240:255]
    s_waitcnt lgkmcnt(0)
    s_waitcnt vmcnt(23)
    s_barrier
    v_mfma_f32_32x32x16_bf16 v[128:143], v[56:59], v[72:75], v[128:143]
    ds_read_b64_tr_b16 v[48:49], v20 offset:24576
    ds_read_b64_tr_b16 v[50:51], v20 offset:25600
    v_mfma_f32_32x32x16_bf16 v[144:159], v[56:59], v[76:79], v[144:159]
    ds_read_b64_tr_b16 v[52:53], v21 offset:24576
    ds_read_b64_tr_b16 v[54:55], v21 offset:25600
    buffer_load_dwordx4 a[48:51], v3, s[56:59], s14 offen offset:2048 sc1
    v_mfma_f32_32x32x16_bf16 v[160:175], v[60:63], v[72:75], v[160:175]
    ds_read_b64_tr_b16 v[32:33], v16 offset:24576
    ds_read_b64_tr_b16 v[34:35], v16 offset:25600
    buffer_load_dwordx4 a[52:55], v3, s[56:59], s15 offen offset:2048 sc1
    v_mfma_f32_32x32x16_bf16 v[176:191], v[60:63], v[76:79], v[176:191]
    ds_read_b64_tr_b16 v[36:37], v17 offset:24576
    ds_read_b64_tr_b16 v[38:39], v17 offset:25600
    buffer_load_dwordx4 a[56:59], v3, s[56:59], s14 offen offset:3072 sc1
    v_mfma_f32_32x32x16_bf16 v[192:207], v[64:67], v[72:75], v[192:207]
    ds_read_b64_tr_b16 v[40:41], v18 offset:24576
    ds_read_b64_tr_b16 v[42:43], v18 offset:25600
    buffer_load_dwordx4 a[60:63], v3, s[56:59], s15 offen offset:3072 sc1
    v_mfma_f32_32x32x16_bf16 v[208:223], v[64:67], v[76:79], v[208:223]
    ds_read_b64_tr_b16 v[44:45], v19 offset:24576
    ds_read_b64_tr_b16 v[46:47], v19 offset:25600
    v_mfma_f32_32x32x16_bf16 v[224:239], v[68:71], v[72:75], v[224:239]
    v_mfma_f32_32x32x16_bf16 v[240:255], v[68:71], v[76:79], v[240:255]
    s_waitcnt lgkmcnt(0)
    s_waitcnt vmcnt(18)
    v_readfirstlane_b32 s54, v28
    s_nop 3
    s_cmp_lt_u32 s54, 2
    s_cbranch_scc1 sequential_preLN__ssm_conv_s4d__geglu_ffn__prompt_kernel_slow_19
sequential_preLN__ssm_conv_s4d__geglu_ffn__prompt_kernel_back_20:
    v_mfma_f32_32x32x16_bf16 v[128:143], v[32:35], v[48:51], v[128:143]
    ds_read_b64_tr_b16 v[72:73], v20 offset:28672
    ds_read_b64_tr_b16 v[74:75], v20 offset:29696
    v_mfma_f32_32x32x16_bf16 v[144:159], v[32:35], v[52:55], v[144:159]
    s_add_u32 s14, s14, 4096
    s_add_u32 s15, s15, 4096
    ds_read_b64_tr_b16 v[76:77], v21 offset:28672
    ds_read_b64_tr_b16 v[78:79], v21 offset:29696
    buffer_load_dwordx4 a[64:67], v3, s[56:59], s14 offen offset:0 sc1
    v_mfma_f32_32x32x16_bf16 v[160:175], v[36:39], v[48:51], v[160:175]
    ds_read_b64_tr_b16 v[56:57], v16 offset:28672
    ds_read_b64_tr_b16 v[58:59], v16 offset:29696
    buffer_load_dwordx4 a[68:71], v3, s[56:59], s15 offen offset:0 sc1
    v_mfma_f32_32x32x16_bf16 v[176:191], v[36:39], v[52:55], v[176:191]
    ds_read_b64_tr_b16 v[60:61], v17 offset:28672
    ds_read_b64_tr_b16 v[62:63], v17 offset:29696
    buffer_load_dwordx4 a[72:75], v3, s[56:59], s14 offen offset:1024 sc1
    v_mfma_f32_32x32x16_bf16 v[192:207], v[40:43], v[48:51], v[192:207]
    ds_read_b64_tr_b16 v[64:65], v18 offset:28672
    ds_read_b64_tr_b16 v[66:67], v18 offset:29696
    buffer_load_dwordx4 a[76:79], v3, s[56:59], s15 offen offset:1024 sc1
    v_mfma_f32_32x32x16_bf16 v[208:223], v[40:43], v[52:55], v[208:223]
    ds_read_b64_tr_b16 v[68:69], v19 offset:28672
    ds_read_b64_tr_b16 v[70:71], v19 offset:29696
    buffer_load_dwordx4 v[80:83], v5, s[60:63], 0 offen sc1
    v_mfma_f32_32x32x16_bf16 v[224:239], v[44:47], v[48:51], v[224:239]
    buffer_load_dwordx4 v[84:87], v5, s[60:63], 0 offen offset:512 sc1
    v_mfma_f32_32x32x16_bf16 v[240:255], v[44:47], v[52:55], v[240:255]
    s_waitcnt lgkmcnt(0)
    s_barrier
    v_mfma_f32_32x32x16_bf16 v[128:143], v[56:59], v[72:75], v[128:143]
    ds_read_b64_tr_b16 v[48:49], v20 offset:49152
    ds_read_b64_tr_b16 v[50:51], v20 offset:50176
    v_mfma_f32_32x32x16_bf16 v[144:159], v[56:59], v[76:79], v[144:159]
    ds_read_b64_tr_b16 v[52:53], v21 offset:49152
    ds_read_b64_tr_b16 v[54:55], v21 offset:50176
    buffer_load_dwordx4 a[80:83], v3, s[56:59], s14 offen offset:2048 sc1
    v_mfma_f32_32x32x16_bf16 v[160:175], v[60:63], v[72:75], v[160:175]
    ds_read_b64_tr_b16 v[32:33], v16 offset:49152
    ds_read_b64_tr_b16 v[34:35], v16 offset:50176
    buffer_load_dwordx4 a[84:87], v3, s[56:59], s15 offen offset:2048 sc1
    v_mfma_f32_32x32x16_bf16 v[176:191], v[60:63], v[76:79], v[176:191]
    ds_read_b64_tr_b16 v[36:37], v17 offset:49152
    ds_read_b64_tr_b16 v[38:39], v17 offset:50176
    buffer_load_dwordx4 a[88:91], v3, s[56:59], s14 offen offset:3072 sc1
    v_mfma_f32_32x32x16_bf16 v[192:207], v[64:67], v[72:75], v[192:207]
    ds_read_b64_tr_b16 v[40:41], v18 offset:49152
    ds_read_b64_tr_b16 v[42:43], v18 offset:50176
    buffer_load_dwordx4 a[92:95], v3, s[56:59], s15 offen offset:3072 sc1
    v_mfma_f32_32x32x16_bf16 v[208:223], v[64:67], v[76:79], v[208:223]
    ds_read_b64_tr_b16 v[44:45], v19 offset:49152
    ds_read_b64_tr_b16 v[46:47], v19 offset:50176
    v_mfma_f32_32x32x16_bf16 v[224:239], v[68:71], v[72:75], v[224:239]
    v_mfma_f32_32x32x16_bf16 v[240:255], v[68:71], v[76:79], v[240:255]
    s_waitcnt lgkmcnt(0)
    v_mfma_f32_32x32x16_bf16 v[128:143], v[32:35], v[48:51], v[128:143]
    ds_read_b64_tr_b16 v[72:73], v20 offset:53248
    ds_read_b64_tr_b16 v[74:75], v20 offset:54272
    v_mfma_f32_32x32x16_bf16 v[144:159], v[32:35], v[52:55], v[144:159]
    s_add_u32 s14, s14, 4096
    s_add_u32 s15, s15, 4096
    ds_read_b64_tr_b16 v[76:77], v21 offset:53248
    ds_read_b64_tr_b16 v[78:79], v21 offset:54272
    buffer_load_dwordx4 a[96:99], v3, s[56:59], s14 offen offset:0 sc1
    v_mfma_f32_32x32x16_bf16 v[160:175], v[36:39], v[48:51], v[160:175]
    ds_read_b64_tr_b16 v[56:57], v16 offset:53248
    ds_read_b64_tr_b16 v[58:59], v16 offset:54272
    buffer_load_dwordx4 a[100:103], v3, s[56:59], s15 offen offset:0 sc1
    v_mfma_f32_32x32x16_bf16 v[176:191], v[36:39], v[52:55], v[176:191]
    ds_read_b64_tr_b16 v[60:61], v17 offset:53248
    ds_read_b64_tr_b16 v[62:63], v17 offset:54272
    buffer_load_dwordx4 a[104:107], v3, s[56:59], s14 offen offset:1024 sc1
    v_mfma_f32_32x32x16_bf16 v[192:207], v[40:43], v[48:51], v[192:207]
    ds_read_b64_tr_b16 v[64:65], v18 offset:53248
    ds_read_b64_tr_b16 v[66:67], v18 offset:54272
    buffer_load_dwordx4 a[108:111], v3, s[56:59], s15 offen offset:1024 sc1
    v_mfma_f32_32x32x16_bf16 v[208:223], v[40:43], v[52:55], v[208:223]
    ds_read_b64_tr_b16 v[68:69], v19 offset:53248
    ds_read_b64_tr_b16 v[70:71], v19 offset:54272
    v_mfma_f32_32x32x16_bf16 v[224:239], v[44:47], v[48:51], v[224:239]
    v_mfma_f32_32x32x16_bf16 v[240:255], v[44:47], v[52:55], v[240:255]
    s_waitcnt lgkmcnt(0)
    s_waitcnt vmcnt(30)
    s_barrier
    v_mfma_f32_32x32x16_bf16 v[128:143], v[56:59], v[72:75], v[128:143]
    ds_read_b64_tr_b16 v[48:49], v26 offset:0
    ds_read_b64_tr_b16 v[50:51], v26 offset:1024
    v_mfma_f32_32x32x16_bf16 v[144:159], v[56:59], v[76:79], v[144:159]
    ds_read_b64_tr_b16 v[52:53], v27 offset:0
    ds_read_b64_tr_b16 v[54:55], v27 offset:1024
    buffer_load_dwordx4 a[112:115], v3, s[56:59], s14 offen offset:2048 sc1
    v_mfma_f32_32x32x16_bf16 v[160:175], v[60:63], v[72:75], v[160:175]
    ds_read_b64_tr_b16 v[32:33], v22 offset:0
    ds_read_b64_tr_b16 v[34:35], v22 offset:1024
    buffer_load_dwordx4 a[116:119], v3, s[56:59], s15 offen offset:2048 sc1
    v_mfma_f32_32x32x16_bf16 v[176:191], v[60:63], v[76:79], v[176:191]
    ds_read_b64_tr_b16 v[36:37], v23 offset:0
    ds_read_b64_tr_b16 v[38:39], v23 offset:1024
    buffer_load_dwordx4 a[120:123], v3, s[56:59], s14 offen offset:3072 sc1
    v_mfma_f32_32x32x16_bf16 v[192:207], v[64:67], v[72:75], v[192:207]
    ds_read_b64_tr_b16 v[40:41], v24 offset:0
    ds_read_b64_tr_b16 v[42:43], v24 offset:1024
    buffer_load_dwordx4 a[124:127], v3, s[56:59], s15 offen offset:3072 sc1
    v_mfma_f32_32x32x16_bf16 v[208:223], v[64:67], v[76:79], v[208:223]
    ds_read_b64_tr_b16 v[44:45], v25 offset:0
    ds_read_b64_tr_b16 v[46:47], v25 offset:1024
    v_mfma_f32_32x32x16_bf16 v[224:239], v[68:71], v[72:75], v[224:239]
    v_mfma_f32_32x32x16_bf16 v[240:255], v[68:71], v[76:79], v[240:255]
    s_waitcnt lgkmcnt(0)
    v_mfma_f32_32x32x16_bf16 v[128:143], v[32:35], v[48:51], v[128:143]
    ds_read_b64_tr_b16 v[72:73], v26 offset:4096
    ds_read_b64_tr_b16 v[74:75], v26 offset:5120
    v_mfma_f32_32x32x16_bf16 v[144:159], v[32:35], v[52:55], v[144:159]
    s_add_u32 s14, s14, 4096
    s_add_u32 s15, s15, 4096
    ds_read_b64_tr_b16 v[76:77], v27 offset:4096
    ds_read_b64_tr_b16 v[78:79], v27 offset:5120
    buffer_load_dwordx4 a[128:131], v3, s[56:59], s14 offen offset:0 sc1
    v_mfma_f32_32x32x16_bf16 v[160:175], v[36:39], v[48:51], v[160:175]
    ds_read_b64_tr_b16 v[56:57], v22 offset:4096
    ds_read_b64_tr_b16 v[58:59], v22 offset:5120
    buffer_load_dwordx4 a[132:135], v3, s[56:59], s15 offen offset:0 sc1
    v_mfma_f32_32x32x16_bf16 v[176:191], v[36:39], v[52:55], v[176:191]
    ds_read_b64_tr_b16 v[60:61], v23 offset:4096
    ds_read_b64_tr_b16 v[62:63], v23 offset:5120
    buffer_load_dwordx4 a[136:139], v3, s[56:59], s14 offen offset:1024 sc1
    v_mfma_f32_32x32x16_bf16 v[192:207], v[40:43], v[48:51], v[192:207]
    ds_read_b64_tr_b16 v[64:65], v24 offset:4096
    ds_read_b64_tr_b16 v[66:67], v24 offset:5120
    buffer_load_dwordx4 a[140:143], v3, s[56:59], s15 offen offset:1024 sc1
    v_mfma_f32_32x32x16_bf16 v[208:223], v[40:43], v[52:55], v[208:223]
    ds_read_b64_tr_b16 v[68:69], v25 offset:4096
    ds_read_b64_tr_b16 v[70:71], v25 offset:5120
    v_mfma_f32_32x32x16_bf16 v[224:239], v[44:47], v[48:51], v[224:239]
    v_mfma_f32_32x32x16_bf16 v[240:255], v[44:47], v[52:55], v[240:255]
    s_waitcnt lgkmcnt(0)
    v_mfma_f32_32x32x16_bf16 v[128:143], v[56:59], v[72:75], v[128:143]
    v_mfma_f32_32x32x16_bf16 v[144:159], v[56:59], v[76:79], v[144:159]
    buffer_load_dwordx4 a[144:147], v3, s[56:59], s14 offen offset:2048 sc1
    v_mfma_f32_32x32x16_bf16 v[160:175], v[60:63], v[72:75], v[160:175]
    buffer_load_dwordx4 a[148:151], v3, s[56:59], s15 offen offset:2048 sc1
    v_mfma_f32_32x32x16_bf16 v[176:191], v[60:63], v[76:79], v[176:191]
    buffer_load_dwordx4 a[152:155], v3, s[56:59], s14 offen offset:3072 sc1
    v_mfma_f32_32x32x16_bf16 v[192:207], v[64:67], v[72:75], v[192:207]
    buffer_load_dwordx4 a[156:159], v3, s[56:59], s15 offen offset:3072 sc1
    v_mfma_f32_32x32x16_bf16 v[208:223], v[64:67], v[76:79], v[208:223]
    v_mfma_f32_32x32x16_bf16 v[224:239], v[68:71], v[72:75], v[224:239]
    v_mfma_f32_32x32x16_bf16 v[240:255], v[68:71], v[76:79], v[240:255]
    s_waitcnt vmcnt(20)
    v_lshrrev_b32 v7, 5, v1
    s_lshl_b32 s27, s17, 8
    v_lshlrev_b32 v6, 5, v7
    v_add_u32 v6, s27, v6
    v_add_u32 v6, 147456, v6
    s_lshl_b32 s26, s20, 2
    s_lshl_b32 s27, s16, 1
    s_add_u32 s26, s26, s27
    s_mul_i32 s26, s26, 112
    s_lshl_b32 s27, s21, 3
    s_add_u32 s26, s26, s27
    s_lshl_b32 s27, s17, 2
    s_add_u32 s26, s26, s27
    s_lshl_b32 s26, s26, 10
    s_add_u32 s27, s26, 114688
    ds_read_b128 v[32:35], v6 offset:0
    ds_read_b128 v[36:39], v6 offset:16
    ds_read_b128 v[40:43], v6 offset:512
    ds_read_b128 v[44:47], v6 offset:528
    ds_read_b128 v[48:51], v6 offset:64
    ds_read_b128 v[52:55], v6 offset:80
    ds_read_b128 v[56:59], v6 offset:576
    ds_read_b128 v[60:63], v6 offset:592
    s_waitcnt lgkmcnt(4)
    v_pk_fma_f32 v[128:129], v[80:81], v[32:33], v[128:129] op_sel_hi:[0,1,1]
    v_pk_fma_f32 v[130:131], v[80:81], v[34:35], v[130:131] op_sel_hi:[0,1,1]
    v_pk_fma_f32 v[132:133], v[80:81], v[36:37], v[132:133] op_sel_hi:[0,1,1]
    v_pk_fma_f32 v[134:135], v[80:81], v[38:39], v[134:135] op_sel_hi:[0,1,1]
    v_pk_fma_f32 v[136:137], v[80:81], v[40:41], v[136:137] op_sel_hi:[0,1,1]
    v_pk_fma_f32 v[138:139], v[80:81], v[42:43], v[138:139] op_sel_hi:[0,1,1]
    v_pk_fma_f32 v[140:141], v[80:81], v[44:45], v[140:141] op_sel_hi:[0,1,1]
    v_pk_fma_f32 v[142:143], v[80:81], v[46:47], v[142:143] op_sel_hi:[0,1,1]
    v_pk_mul_f32 v[96:97], v[128:129], v[128:129]
    v_pk_mul_f32 v[100:101], v[130:131], v[130:131]
    v_pk_mul_f32 v[104:105], v[132:133], v[132:133]
    v_pk_mul_f32 v[108:109], v[134:135], v[134:135]
    v_pk_fma_f32 v[96:97], v[96:97], v[82:83], v[80:81] op_sel:[0,0,1] op_sel_hi:[1,0,1]
    v_pk_fma_f32 v[100:101], v[100:101], v[82:83], v[80:81] op_sel:[0,0,1] op_sel_hi:[1,0,1]
    v_pk_fma_f32 v[104:105], v[104:105], v[82:83], v[80:81] op_sel:[0,0,1] op_sel_hi:[1,0,1]
    v_pk_fma_f32 v[108:109], v[108:109], v[82:83], v[80:81] op_sel:[0,0,1] op_sel_hi:[1,0,1]
    v_pk_mul_f32 v[96:97], v[96:97], v[128:129]
    v_pk_mul_f32 v[100:101], v[100:101], v[130:131]
    v_pk_mul_f32 v[104:105], v[104:105], v[132:133]
    v_pk_mul_f32 v[108:109], v[108:109], v[134:135]
    v_exp_f32 v96, v96
    v_exp_f32 v100, v100
    v_exp_f32 v104, v104
    v_exp_f32 v108, v108
    v_exp_f32 v97, v97
    v_exp_f32 v101, v101
    v_exp_f32 v105, v105
    v_exp_f32 v109, v109
    v_pk_mul_f32 v[136:137], v[136:137], v[128:129]
    v_pk_mul_f32 v[138:139], v[138:139], v[130:131]
    v_pk_mul_f32 v[140:141], v[140:141], v[132:133]
    v_pk_mul_f32 v[142:143], v[142:143], v[134:135]
    v_pk_fma_f32 v[96:97], v[96:97], v[82:83], v[82:83] op_sel:[0,1,1] op_sel_hi:[1,1,1]
    v_pk_fma_f32 v[100:101], v[100:101], v[82:83], v[82:83] op_sel:[0,1,1] op_sel_hi:[1,1,1]
    v_pk_fma_f32 v[104:105], v[104:105], v[82:83], v[82:83] op_sel:[0,1,1] op_sel_hi:[1,1,1]
    v_pk_fma_f32 v[108:109], v[108:109], v[82:83], v[82:83] op_sel:[0,1,1] op_sel_hi:[1,1,1]
    v_rcp_f32 v96, v96
    v_rcp_f32 v100, v100
    v_rcp_f32 v104, v104
    v_rcp_f32 v108, v108
    v_rcp_f32 v97, v97
    v_rcp_f32 v101, v101
    v_rcp_f32 v105, v105
    v_rcp_f32 v109, v109
    v_pk_mul_f32 v[136:137], v[136:137], v[96:97]
    v_pk_mul_f32 v[138:139], v[138:139], v[100:101]
    v_pk_mul_f32 v[140:141], v[140:141], v[104:105]
    v_pk_mul_f32 v[142:143], v[142:143], v[108:109]
    v_cvt_pk_bf16_f32 v16, v136, v137
    v_cvt_pk_bf16_f32 v17, v138, v139
    v_cvt_pk_bf16_f32 v18, v140, v141
    v_cvt_pk_bf16_f32 v19, v142, v143
    buffer_store_dwordx4 v[16:19], v3, s[44:47], s26 offen offset:0 sc1
    v_pk_fma_f32 v[144:145], v[84:85], v[32:33], v[144:145] op_sel_hi:[0,1,1]
    v_pk_fma_f32 v[146:147], v[84:85], v[34:35], v[146:147] op_sel_hi:[0,1,1]
    v_pk_fma_f32 v[148:149], v[84:85], v[36:37], v[148:149] op_sel_hi:[0,1,1]
    v_pk_fma_f32 v[150:151], v[84:85], v[38:39], v[150:151] op_sel_hi:[0,1,1]
    v_pk_fma_f32 v[152:153], v[84:85], v[40:41], v[152:153] op_sel_hi:[0,1,1]
    v_pk_fma_f32 v[154:155], v[84:85], v[42:43], v[154:155] op_sel_hi:[0,1,1]
    v_pk_fma_f32 v[156:157], v[84:85], v[44:45], v[156:157] op_sel_hi:[0,1,1]
    v_pk_fma_f32 v[158:159], v[84:85], v[46:47], v[158:159] op_sel_hi:[0,1,1]
    v_pk_mul_f32 v[96:97], v[144:145], v[144:145]
    v_pk_mul_f32 v[100:101], v[146:147], v[146:147]
    v_pk_mul_f32 v[104:105], v[148:149], v[148:149]
    v_pk_mul_f32 v[108:109], v[150:151], v[150:151]
    v_pk_fma_f32 v[96:97], v[96:97], v[86:87], v[84:85] op_sel:[0,0,1] op_sel_hi:[1,0,1]
    v_pk_fma_f32 v[100:101], v[100:101], v[86:87], v[84:85] op_sel:[0,0,1] op_sel_hi:[1,0,1]
    v_pk_fma_f32 v[104:105], v[104:105], v[86:87], v[84:85] op_sel:[0,0,1] op_sel_hi:[1,0,1]
    v_pk_fma_f32 v[108:109], v[108:109], v[86:87], v[84:85] op_sel:[0,0,1] op_sel_hi:[1,0,1]
    v_pk_mul_f32 v[96:97], v[96:97], v[144:145]
    v_pk_mul_f32 v[100:101], v[100:101], v[146:147]
    v_pk_mul_f32 v[104:105], v[104:105], v[148:149]
    v_pk_mul_f32 v[108:109], v[108:109], v[150:151]
    v_exp_f32 v96, v96
    v_exp_f32 v100, v100
    v_exp_f32 v104, v104
    v_exp_f32 v108, v108
    v_exp_f32 v97, v97
    v_exp_f32 v101, v101
    v_exp_f32 v105, v105
    v_exp_f32 v109, v109
    v_pk_mul_f32 v[152:153], v[152:153], v[144:145]
    v_pk_mul_f32 v[154:155], v[154:155], v[146:147]
    v_pk_mul_f32 v[156:157], v[156:157], v[148:149]
    v_pk_mul_f32 v[158:159], v[158:159], v[150:151]
    v_pk_fma_f32 v[96:97], v[96:97], v[86:87], v[86:87] op_sel:[0,1,1] op_sel_hi:[1,1,1]
    v_pk_fma_f32 v[100:101], v[100:101], v[86:87], v[86:87] op_sel:[0,1,1] op_sel_hi:[1,1,1]
    v_pk_fma_f32 v[104:105], v[104:105], v[86:87], v[86:87] op_sel:[0,1,1] op_sel_hi:[1,1,1]
    v_pk_fma_f32 v[108:109], v[108:109], v[86:87], v[86:87] op_sel:[0,1,1] op_sel_hi:[1,1,1]
    v_rcp_f32 v96, v96
    v_rcp_f32 v100, v100
    v_rcp_f32 v104, v104
    v_rcp_f32 v108, v108
    v_rcp_f32 v97, v97
    v_rcp_f32 v101, v101
    v_rcp_f32 v105, v105
    v_rcp_f32 v109, v109
    v_pk_mul_f32 v[152:153], v[152:153], v[96:97]
    v_pk_mul_f32 v[154:155], v[154:155], v[100:101]
    v_pk_mul_f32 v[156:157], v[156:157], v[104:105]
    v_pk_mul_f32 v[158:159], v[158:159], v[108:109]
    v_cvt_pk_bf16_f32 v20, v152, v153
    v_cvt_pk_bf16_f32 v21, v154, v155
    v_cvt_pk_bf16_f32 v22, v156, v157
    v_cvt_pk_bf16_f32 v23, v158, v159
    buffer_store_dwordx4 v[20:23], v3, s[44:47], s27 offen offset:0 sc1
    ds_read_b128 v[32:35], v6 offset:128
    ds_read_b128 v[36:39], v6 offset:144
    ds_read_b128 v[40:43], v6 offset:640
    ds_read_b128 v[44:47], v6 offset:656
    s_waitcnt lgkmcnt(4)
    v_pk_fma_f32 v[160:161], v[80:81], v[48:49], v[160:161] op_sel_hi:[0,1,1]
    v_pk_fma_f32 v[162:163], v[80:81], v[50:51], v[162:163] op_sel_hi:[0,1,1]
    v_pk_fma_f32 v[164:165], v[80:81], v[52:53], v[164:165] op_sel_hi:[0,1,1]
    v_pk_fma_f32 v[166:167], v[80:81], v[54:55], v[166:167] op_sel_hi:[0,1,1]
    v_pk_fma_f32 v[168:169], v[80:81], v[56:57], v[168:169] op_sel_hi:[0,1,1]
    v_pk_fma_f32 v[170:171], v[80:81], v[58:59], v[170:171] op_sel_hi:[0,1,1]
    v_pk_fma_f32 v[172:173], v[80:81], v[60:61], v[172:173] op_sel_hi:[0,1,1]
    v_pk_fma_f32 v[174:175], v[80:81], v[62:63], v[174:175] op_sel_hi:[0,1,1]
    v_pk_mul_f32 v[96:97], v[160:161], v[160:161]
    v_pk_mul_f32 v[100:101], v[162:163], v[162:163]
    v_pk_mul_f32 v[104:105], v[164:165], v[164:165]
    v_pk_mul_f32 v[108:109], v[166:167], v[166:167]
    v_pk_fma_f32 v[96:97], v[96:97], v[82:83], v[80:81] op_sel:[0,0,1] op_sel_hi:[1,0,1]
    v_pk_fma_f32 v[100:101], v[100:101], v[82:83], v[80:81] op_sel:[0,0,1] op_sel_hi:[1,0,1]
    v_pk_fma_f32 v[104:105], v[104:105], v[82:83], v[80:81] op_sel:[0,0,1] op_sel_hi:[1,0,1]
    v_pk_fma_f32 v[108:109], v[108:109], v[82:83], v[80:81] op_sel:[0,0,1] op_sel_hi:[1,0,1]
    v_pk_mul_f32 v[96:97], v[96:97], v[160:161]
    v_pk_mul_f32 v[100:101], v[100:101], v[162:163]
    v_pk_mul_f32 v[104:105], v[104:105], v[164:165]
    v_pk_mul_f32 v[108:109], v[108:109], v[166:167]
    v_exp_f32 v96, v96
    v_exp_f32 v100, v100
    v_exp_f32 v104, v104
    v_exp_f32 v108, v108
    v_exp_f32 v97, v97
    v_exp_f32 v101, v101
    v_exp_f32 v105, v105
    v_exp_f32 v109, v109
    v_pk_mul_f32 v[168:169], v[168:169], v[160:161]
    v_pk_mul_f32 v[170:171], v[170:171], v[162:163]
    v_pk_mul_f32 v[172:173], v[172:173], v[164:165]
    v_pk_mul_f32 v[174:175], v[174:175], v[166:167]
    v_pk_fma_f32 v[96:97], v[96:97], v[82:83], v[82:83] op_sel:[0,1,1] op_sel_hi:[1,1,1]
    v_pk_fma_f32 v[100:101], v[100:101], v[82:83], v[82:83] op_sel:[0,1,1] op_sel_hi:[1,1,1]
    v_pk_fma_f32 v[104:105], v[104:105], v[82:83], v[82:83] op_sel:[0,1,1] op_sel_hi:[1,1,1]
    v_pk_fma_f32 v[108:109], v[108:109], v[82:83], v[82:83] op_sel:[0,1,1] op_sel_hi:[1,1,1]
    v_rcp_f32 v96, v96
    v_rcp_f32 v100, v100
    v_rcp_f32 v104, v104
    v_rcp_f32 v108, v108
    v_rcp_f32 v97, v97
    v_rcp_f32 v101, v101
    v_rcp_f32 v105, v105
    v_rcp_f32 v109, v109
    v_pk_mul_f32 v[168:169], v[168:169], v[96:97]
    v_pk_mul_f32 v[170:171], v[170:171], v[100:101]
    v_pk_mul_f32 v[172:173], v[172:173], v[104:105]
    v_pk_mul_f32 v[174:175], v[174:175], v[108:109]
    v_cvt_pk_bf16_f32 v16, v168, v169
    v_cvt_pk_bf16_f32 v17, v170, v171
    v_cvt_pk_bf16_f32 v18, v172, v173
    v_cvt_pk_bf16_f32 v19, v174, v175
    buffer_store_dwordx4 v[16:19], v3, s[44:47], s26 offen offset:1024 sc1
    v_pk_fma_f32 v[176:177], v[84:85], v[48:49], v[176:177] op_sel_hi:[0,1,1]
    v_pk_fma_f32 v[178:179], v[84:85], v[50:51], v[178:179] op_sel_hi:[0,1,1]
    v_pk_fma_f32 v[180:181], v[84:85], v[52:53], v[180:181] op_sel_hi:[0,1,1]
    v_pk_fma_f32 v[182:183], v[84:85], v[54:55], v[182:183] op_sel_hi:[0,1,1]
    v_pk_fma_f32 v[184:185], v[84:85], v[56:57], v[184:185] op_sel_hi:[0,1,1]
    v_pk_fma_f32 v[186:187], v[84:85], v[58:59], v[186:187] op_sel_hi:[0,1,1]
    v_pk_fma_f32 v[188:189], v[84:85], v[60:61], v[188:189] op_sel_hi:[0,1,1]
    v_pk_fma_f32 v[190:191], v[84:85], v[62:63], v[190:191] op_sel_hi:[0,1,1]
    v_pk_mul_f32 v[96:97], v[176:177], v[176:177]
    v_pk_mul_f32 v[100:101], v[178:179], v[178:179]
    v_pk_mul_f32 v[104:105], v[180:181], v[180:181]
    v_pk_mul_f32 v[108:109], v[182:183], v[182:183]
    v_pk_fma_f32 v[96:97], v[96:97], v[86:87], v[84:85] op_sel:[0,0,1] op_sel_hi:[1,0,1]
    v_pk_fma_f32 v[100:101], v[100:101], v[86:87], v[84:85] op_sel:[0,0,1] op_sel_hi:[1,0,1]
    v_pk_fma_f32 v[104:105], v[104:105], v[86:87], v[84:85] op_sel:[0,0,1] op_sel_hi:[1,0,1]
    v_pk_fma_f32 v[108:109], v[108:109], v[86:87], v[84:85] op_sel:[0,0,1] op_sel_hi:[1,0,1]
    v_pk_mul_f32 v[96:97], v[96:97], v[176:177]
    v_pk_mul_f32 v[100:101], v[100:101], v[178:179]
    v_pk_mul_f32 v[104:105], v[104:105], v[180:181]
    v_pk_mul_f32 v[108:109], v[108:109], v[182:183]
    v_exp_f32 v96, v96
    v_exp_f32 v100, v100
    v_exp_f32 v104, v104
    v_exp_f32 v108, v108
    v_exp_f32 v97, v97
    v_exp_f32 v101, v101
    v_exp_f32 v105, v105
    v_exp_f32 v109, v109
    v_pk_mul_f32 v[184:185], v[184:185], v[176:177]
    v_pk_mul_f32 v[186:187], v[186:187], v[178:179]
    v_pk_mul_f32 v[188:189], v[188:189], v[180:181]
    v_pk_mul_f32 v[190:191], v[190:191], v[182:183]
    v_pk_fma_f32 v[96:97], v[96:97], v[86:87], v[86:87] op_sel:[0,1,1] op_sel_hi:[1,1,1]
    v_pk_fma_f32 v[100:101], v[100:101], v[86:87], v[86:87] op_sel:[0,1,1] op_sel_hi:[1,1,1]
    v_pk_fma_f32 v[104:105], v[104:105], v[86:87], v[86:87] op_sel:[0,1,1] op_sel_hi:[1,1,1]
    v_pk_fma_f32 v[108:109], v[108:109], v[86:87], v[86:87] op_sel:[0,1,1] op_sel_hi:[1,1,1]
    v_rcp_f32 v96, v96
    v_rcp_f32 v100, v100
    v_rcp_f32 v104, v104
    v_rcp_f32 v108, v108
    v_rcp_f32 v97, v97
    v_rcp_f32 v101, v101
    v_rcp_f32 v105, v105
    v_rcp_f32 v109, v109
    v_pk_mul_f32 v[184:185], v[184:185], v[96:97]
    v_pk_mul_f32 v[186:187], v[186:187], v[100:101]
    v_pk_mul_f32 v[188:189], v[188:189], v[104:105]
    v_pk_mul_f32 v[190:191], v[190:191], v[108:109]
    v_cvt_pk_bf16_f32 v20, v184, v185
    v_cvt_pk_bf16_f32 v21, v186, v187
    v_cvt_pk_bf16_f32 v22, v188, v189
    v_cvt_pk_bf16_f32 v23, v190, v191
    buffer_store_dwordx4 v[20:23], v3, s[44:47], s27 offen offset:1024 sc1
    ds_read_b128 v[48:51], v6 offset:192
    ds_read_b128 v[52:55], v6 offset:208
    ds_read_b128 v[56:59], v6 offset:704
    ds_read_b128 v[60:63], v6 offset:720
    s_waitcnt lgkmcnt(4)
    v_pk_fma_f32 v[192:193], v[80:81], v[32:33], v[192:193] op_sel_hi:[0,1,1]
    v_pk_fma_f32 v[194:195], v[80:81], v[34:35], v[194:195] op_sel_hi:[0,1,1]
    v_pk_fma_f32 v[196:197], v[80:81], v[36:37], v[196:197] op_sel_hi:[0,1,1]
    v_pk_fma_f32 v[198:199], v[80:81], v[38:39], v[198:199] op_sel_hi:[0,1,1]
    v_pk_fma_f32 v[200:201], v[80:81], v[40:41], v[200:201] op_sel_hi:[0,1,1]
    v_pk_fma_f32 v[202:203], v[80:81], v[42:43], v[202:203] op_sel_hi:[0,1,1]
    v_pk_fma_f32 v[204:205], v[80:81], v[44:45], v[204:205] op_sel_hi:[0,1,1]
    v_pk_fma_f32 v[206:207], v[80:81], v[46:47], v[206:207] op_sel_hi:[0,1,1]
    v_pk_mul_f32 v[96:97], v[192:193], v[192:193]
    v_pk_mul_f32 v[100:101], v[194:195], v[194:195]
    v_pk_mul_f32 v[104:105], v[196:197], v[196:197]
    v_pk_mul_f32 v[108:109], v[198:199], v[198:199]
    v_pk_fma_f32 v[96:97], v[96:97], v[82:83], v[80:81] op_sel:[0,0,1] op_sel_hi:[1,0,1]
    v_pk_fma_f32 v[100:101], v[100:101], v[82:83], v[80:81] op_sel:[0,0,1] op_sel_hi:[1,0,1]
    v_pk_fma_f32 v[104:105], v[104:105], v[82:83], v[80:81] op_sel:[0,0,1] op_sel_hi:[1,0,1]
    v_pk_fma_f32 v[108:109], v[108:109], v[82:83], v[80:81] op_sel:[0,0,1] op_sel_hi:[1,0,1]
    v_pk_mul_f32 v[96:97], v[96:97], v[192:193]
    v_pk_mul_f32 v[100:101], v[100:101], v[194:195]
    v_pk_mul_f32 v[104:105], v[104:105], v[196:197]
    v_pk_mul_f32 v[108:109], v[108:109], v[198:199]
    v_exp_f32 v96, v96
    v_exp_f32 v100, v100
    v_exp_f32 v104, v104
    v_exp_f32 v108, v108
    v_exp_f32 v97, v97
    v_exp_f32 v101, v101
    v_exp_f32 v105, v105
    v_exp_f32 v109, v109
    v_pk_mul_f32 v[200:201], v[200:201], v[192:193]
    v_pk_mul_f32 v[202:203], v[202:203], v[194:195]
    v_pk_mul_f32 v[204:205], v[204:205], v[196:197]
    v_pk_mul_f32 v[206:207], v[206:207], v[198:199]
    v_pk_fma_f32 v[96:97], v[96:97], v[82:83], v[82:83] op_sel:[0,1,1] op_sel_hi:[1,1,1]
    v_pk_fma_f32 v[100:101], v[100:101], v[82:83], v[82:83] op_sel:[0,1,1] op_sel_hi:[1,1,1]
    v_pk_fma_f32 v[104:105], v[104:105], v[82:83], v[82:83] op_sel:[0,1,1] op_sel_hi:[1,1,1]
    v_pk_fma_f32 v[108:109], v[108:109], v[82:83], v[82:83] op_sel:[0,1,1] op_sel_hi:[1,1,1]
    v_rcp_f32 v96, v96
    v_rcp_f32 v100, v100
    v_rcp_f32 v104, v104
    v_rcp_f32 v108, v108
    v_rcp_f32 v97, v97
    v_rcp_f32 v101, v101
    v_rcp_f32 v105, v105
    v_rcp_f32 v109, v109
    v_pk_mul_f32 v[200:201], v[200:201], v[96:97]
    v_pk_mul_f32 v[202:203], v[202:203], v[100:101]
    v_pk_mul_f32 v[204:205], v[204:205], v[104:105]
    v_pk_mul_f32 v[206:207], v[206:207], v[108:109]
    v_cvt_pk_bf16_f32 v16, v200, v201
    v_cvt_pk_bf16_f32 v17, v202, v203
    v_cvt_pk_bf16_f32 v18, v204, v205
    v_cvt_pk_bf16_f32 v19, v206, v207
    buffer_store_dwordx4 v[16:19], v3, s[44:47], s26 offen offset:2048 sc1
    v_pk_fma_f32 v[208:209], v[84:85], v[32:33], v[208:209] op_sel_hi:[0,1,1]
    v_pk_fma_f32 v[210:211], v[84:85], v[34:35], v[210:211] op_sel_hi:[0,1,1]
    v_pk_fma_f32 v[212:213], v[84:85], v[36:37], v[212:213] op_sel_hi:[0,1,1]
    v_pk_fma_f32 v[214:215], v[84:85], v[38:39], v[214:215] op_sel_hi:[0,1,1]
    v_pk_fma_f32 v[216:217], v[84:85], v[40:41], v[216:217] op_sel_hi:[0,1,1]
    v_pk_fma_f32 v[218:219], v[84:85], v[42:43], v[218:219] op_sel_hi:[0,1,1]
    v_pk_fma_f32 v[220:221], v[84:85], v[44:45], v[220:221] op_sel_hi:[0,1,1]
    v_pk_fma_f32 v[222:223], v[84:85], v[46:47], v[222:223] op_sel_hi:[0,1,1]
    v_pk_mul_f32 v[96:97], v[208:209], v[208:209]
    v_pk_mul_f32 v[100:101], v[210:211], v[210:211]
    v_pk_mul_f32 v[104:105], v[212:213], v[212:213]
    v_pk_mul_f32 v[108:109], v[214:215], v[214:215]
    v_pk_fma_f32 v[96:97], v[96:97], v[86:87], v[84:85] op_sel:[0,0,1] op_sel_hi:[1,0,1]
    v_pk_fma_f32 v[100:101], v[100:101], v[86:87], v[84:85] op_sel:[0,0,1] op_sel_hi:[1,0,1]
    v_pk_fma_f32 v[104:105], v[104:105], v[86:87], v[84:85] op_sel:[0,0,1] op_sel_hi:[1,0,1]
    v_pk_fma_f32 v[108:109], v[108:109], v[86:87], v[84:85] op_sel:[0,0,1] op_sel_hi:[1,0,1]
    v_pk_mul_f32 v[96:97], v[96:97], v[208:209]
    v_pk_mul_f32 v[100:101], v[100:101], v[210:211]
    v_pk_mul_f32 v[104:105], v[104:105], v[212:213]
    v_pk_mul_f32 v[108:109], v[108:109], v[214:215]
    v_exp_f32 v96, v96
    v_exp_f32 v100, v100
    v_exp_f32 v104, v104
    v_exp_f32 v108, v108
    v_exp_f32 v97, v97
    v_exp_f32 v101, v101
    v_exp_f32 v105, v105
    v_exp_f32 v109, v109
    v_pk_mul_f32 v[216:217], v[216:217], v[208:209]
    v_pk_mul_f32 v[218:219], v[218:219], v[210:211]
    v_pk_mul_f32 v[220:221], v[220:221], v[212:213]
    v_pk_mul_f32 v[222:223], v[222:223], v[214:215]
    v_pk_fma_f32 v[96:97], v[96:97], v[86:87], v[86:87] op_sel:[0,1,1] op_sel_hi:[1,1,1]
    v_pk_fma_f32 v[100:101], v[100:101], v[86:87], v[86:87] op_sel:[0,1,1] op_sel_hi:[1,1,1]
    v_pk_fma_f32 v[104:105], v[104:105], v[86:87], v[86:87] op_sel:[0,1,1] op_sel_hi:[1,1,1]
    v_pk_fma_f32 v[108:109], v[108:109], v[86:87], v[86:87] op_sel:[0,1,1] op_sel_hi:[1,1,1]
    v_rcp_f32 v96, v96
    v_rcp_f32 v100, v100
    v_rcp_f32 v104, v104
    v_rcp_f32 v108, v108
    v_rcp_f32 v97, v97
    v_rcp_f32 v101, v101
    v_rcp_f32 v105, v105
    v_rcp_f32 v109, v109
    v_pk_mul_f32 v[216:217], v[216:217], v[96:97]
    v_pk_mul_f32 v[218:219], v[218:219], v[100:101]
    v_pk_mul_f32 v[220:221], v[220:221], v[104:105]
    v_pk_mul_f32 v[222:223], v[222:223], v[108:109]
    v_cvt_pk_bf16_f32 v20, v216, v217
    v_cvt_pk_bf16_f32 v21, v218, v219
    v_cvt_pk_bf16_f32 v22, v220, v221
    v_cvt_pk_bf16_f32 v23, v222, v223
    buffer_store_dwordx4 v[20:23], v3, s[44:47], s27 offen offset:2048 sc1
    s_waitcnt lgkmcnt(0)
    v_pk_fma_f32 v[224:225], v[80:81], v[48:49], v[224:225] op_sel_hi:[0,1,1]
    v_pk_fma_f32 v[226:227], v[80:81], v[50:51], v[226:227] op_sel_hi:[0,1,1]
    v_pk_fma_f32 v[228:229], v[80:81], v[52:53], v[228:229] op_sel_hi:[0,1,1]
    v_pk_fma_f32 v[230:231], v[80:81], v[54:55], v[230:231] op_sel_hi:[0,1,1]
    v_pk_fma_f32 v[232:233], v[80:81], v[56:57], v[232:233] op_sel_hi:[0,1,1]
    v_pk_fma_f32 v[234:235], v[80:81], v[58:59], v[234:235] op_sel_hi:[0,1,1]
    v_pk_fma_f32 v[236:237], v[80:81], v[60:61], v[236:237] op_sel_hi:[0,1,1]
    v_pk_fma_f32 v[238:239], v[80:81], v[62:63], v[238:239] op_sel_hi:[0,1,1]
    v_pk_mul_f32 v[96:97], v[224:225], v[224:225]
    v_pk_mul_f32 v[100:101], v[226:227], v[226:227]
    v_pk_mul_f32 v[104:105], v[228:229], v[228:229]
    v_pk_mul_f32 v[108:109], v[230:231], v[230:231]
    v_pk_fma_f32 v[96:97], v[96:97], v[82:83], v[80:81] op_sel:[0,0,1] op_sel_hi:[1,0,1]
    v_pk_fma_f32 v[100:101], v[100:101], v[82:83], v[80:81] op_sel:[0,0,1] op_sel_hi:[1,0,1]
    v_pk_fma_f32 v[104:105], v[104:105], v[82:83], v[80:81] op_sel:[0,0,1] op_sel_hi:[1,0,1]
    v_pk_fma_f32 v[108:109], v[108:109], v[82:83], v[80:81] op_sel:[0,0,1] op_sel_hi:[1,0,1]
    v_pk_mul_f32 v[96:97], v[96:97], v[224:225]
    v_pk_mul_f32 v[100:101], v[100:101], v[226:227]
    v_pk_mul_f32 v[104:105], v[104:105], v[228:229]
    v_pk_mul_f32 v[108:109], v[108:109], v[230:231]
    v_exp_f32 v96, v96
    v_exp_f32 v100, v100
    v_exp_f32 v104, v104
    v_exp_f32 v108, v108
    v_exp_f32 v97, v97
    v_exp_f32 v101, v101
    v_exp_f32 v105, v105
    v_exp_f32 v109, v109
    v_pk_mul_f32 v[232:233], v[232:233], v[224:225]
    v_pk_mul_f32 v[234:235], v[234:235], v[226:227]
    v_pk_mul_f32 v[236:237], v[236:237], v[228:229]
    v_pk_mul_f32 v[238:239], v[238:239], v[230:231]
    v_pk_fma_f32 v[96:97], v[96:97], v[82:83], v[82:83] op_sel:[0,1,1] op_sel_hi:[1,1,1]
    v_pk_fma_f32 v[100:101], v[100:101], v[82:83], v[82:83] op_sel:[0,1,1] op_sel_hi:[1,1,1]
    v_pk_fma_f32 v[104:105], v[104:105], v[82:83], v[82:83] op_sel:[0,1,1] op_sel_hi:[1,1,1]
    v_pk_fma_f32 v[108:109], v[108:109], v[82:83], v[82:83] op_sel:[0,1,1] op_sel_hi:[1,1,1]
    v_rcp_f32 v96, v96
    v_rcp_f32 v100, v100
    v_rcp_f32 v104, v104
    v_rcp_f32 v108, v108
    v_rcp_f32 v97, v97
    v_rcp_f32 v101, v101
    v_rcp_f32 v105, v105
    v_rcp_f32 v109, v109
    v_pk_mul_f32 v[232:233], v[232:233], v[96:97]
    v_pk_mul_f32 v[234:235], v[234:235], v[100:101]
    v_pk_mul_f32 v[236:237], v[236:237], v[104:105]
    v_pk_mul_f32 v[238:239], v[238:239], v[108:109]
    v_cvt_pk_bf16_f32 v16, v232, v233
    v_cvt_pk_bf16_f32 v17, v234, v235
    v_cvt_pk_bf16_f32 v18, v236, v237
    v_cvt_pk_bf16_f32 v19, v238, v239
    buffer_store_dwordx4 v[16:19], v3, s[44:47], s26 offen offset:3072 sc1
    v_pk_fma_f32 v[240:241], v[84:85], v[48:49], v[240:241] op_sel_hi:[0,1,1]
    v_pk_fma_f32 v[242:243], v[84:85], v[50:51], v[242:243] op_sel_hi:[0,1,1]
    v_pk_fma_f32 v[244:245], v[84:85], v[52:53], v[244:245] op_sel_hi:[0,1,1]
    v_pk_fma_f32 v[246:247], v[84:85], v[54:55], v[246:247] op_sel_hi:[0,1,1]
    v_pk_fma_f32 v[248:249], v[84:85], v[56:57], v[248:249] op_sel_hi:[0,1,1]
    v_pk_fma_f32 v[250:251], v[84:85], v[58:59], v[250:251] op_sel_hi:[0,1,1]
    v_pk_fma_f32 v[252:253], v[84:85], v[60:61], v[252:253] op_sel_hi:[0,1,1]
    v_pk_fma_f32 v[254:255], v[84:85], v[62:63], v[254:255] op_sel_hi:[0,1,1]
    v_pk_mul_f32 v[96:97], v[240:241], v[240:241]
    v_pk_mul_f32 v[100:101], v[242:243], v[242:243]
    v_pk_mul_f32 v[104:105], v[244:245], v[244:245]
    v_pk_mul_f32 v[108:109], v[246:247], v[246:247]
    v_pk_fma_f32 v[96:97], v[96:97], v[86:87], v[84:85] op_sel:[0,0,1] op_sel_hi:[1,0,1]
    v_pk_fma_f32 v[100:101], v[100:101], v[86:87], v[84:85] op_sel:[0,0,1] op_sel_hi:[1,0,1]
    v_pk_fma_f32 v[104:105], v[104:105], v[86:87], v[84:85] op_sel:[0,0,1] op_sel_hi:[1,0,1]
    v_pk_fma_f32 v[108:109], v[108:109], v[86:87], v[84:85] op_sel:[0,0,1] op_sel_hi:[1,0,1]
    v_pk_mul_f32 v[96:97], v[96:97], v[240:241]
    v_pk_mul_f32 v[100:101], v[100:101], v[242:243]
    v_pk_mul_f32 v[104:105], v[104:105], v[244:245]
    v_pk_mul_f32 v[108:109], v[108:109], v[246:247]
    v_exp_f32 v96, v96
    v_exp_f32 v100, v100
    v_exp_f32 v104, v104
    v_exp_f32 v108, v108
    v_exp_f32 v97, v97
    v_exp_f32 v101, v101
    v_exp_f32 v105, v105
    v_exp_f32 v109, v109
    v_pk_mul_f32 v[248:249], v[248:249], v[240:241]
    v_pk_mul_f32 v[250:251], v[250:251], v[242:243]
    v_pk_mul_f32 v[252:253], v[252:253], v[244:245]
    v_pk_mul_f32 v[254:255], v[254:255], v[246:247]
    v_pk_fma_f32 v[96:97], v[96:97], v[86:87], v[86:87] op_sel:[0,1,1] op_sel_hi:[1,1,1]
    v_pk_fma_f32 v[100:101], v[100:101], v[86:87], v[86:87] op_sel:[0,1,1] op_sel_hi:[1,1,1]
    v_pk_fma_f32 v[104:105], v[104:105], v[86:87], v[86:87] op_sel:[0,1,1] op_sel_hi:[1,1,1]
    v_pk_fma_f32 v[108:109], v[108:109], v[86:87], v[86:87] op_sel:[0,1,1] op_sel_hi:[1,1,1]
    v_rcp_f32 v96, v96
    v_rcp_f32 v100, v100
    v_rcp_f32 v104, v104
    v_rcp_f32 v108, v108
    v_rcp_f32 v97, v97
    v_rcp_f32 v101, v101
    v_rcp_f32 v105, v105
    v_rcp_f32 v109, v109
    v_pk_mul_f32 v[248:249], v[248:249], v[96:97]
    v_pk_mul_f32 v[250:251], v[250:251], v[100:101]
    v_pk_mul_f32 v[252:253], v[252:253], v[104:105]
    v_pk_mul_f32 v[254:255], v[254:255], v[108:109]
    v_cvt_pk_bf16_f32 v20, v248, v249
    v_cvt_pk_bf16_f32 v21, v250, v251
    v_cvt_pk_bf16_f32 v22, v252, v253
    v_cvt_pk_bf16_f32 v23, v254, v255
    buffer_store_dwordx4 v[20:23], v3, s[44:47], s27 offen offset:3072 sc1
    v_lshrrev_b32 v5, 3, v1
    v_and_b32 v6, 7, v1
    s_lshl_b32 s50, s13, 6
    s_lshl_b32 s52, s18, 4
    s_add_u32 s50, s50, s52
    v_add_u32 v7, s50, v5
    v_lshlrev_b32 v7, 12, v7
    v_lshl_add_u32 v7, v6, 4, v7
    s_lshl_b32 s50, s12, 7
    buffer_load_dwordx4 v[8:11], v7, s[36:39], s50 offen sc1
    s_add_u32 s50, s50, 32768
    buffer_load_dwordx4 v[12:15], v7, s[36:39], s50 offen sc1
    v_add_u32 v7, s52, v5
    v_mul_u32_u24 v7, 144, v7
    v_lshl_add_u32 v7, v6, 4, v7
    v_add_u32 v7, 69632, v7
    s_add_u32 s14, s14, 4096
    s_add_u32 s15, s15, 4096
    buffer_load_dwordx4 a[160:163], v3, s[56:59], s14 offen offset:0 sc1
    buffer_load_dwordx4 a[164:167], v3, s[56:59], s15 offen offset:0 sc1
    buffer_load_dwordx4 a[168:171], v3, s[56:59], s14 offen offset:1024 sc1
    buffer_load_dwordx4 a[172:175], v3, s[56:59], s15 offen offset:1024 sc1
    buffer_load_dwordx4 a[176:179], v3, s[56:59], s14 offen offset:2048 sc1
    buffer_load_dwordx4 a[180:183], v3, s[56:59], s15 offen offset:2048 sc1
    buffer_load_dwordx4 a[184:187], v3, s[56:59], s14 offen offset:3072 sc1
    buffer_load_dwordx4 a[188:191], v3, s[56:59], s15 offen offset:3072 sc1
    s_waitcnt vmcnt(10)
    s_barrier
    s_cmp_lg_u32 s18, 0
    s_cbranch_scc1 sequential_preLN__ssm_conv_s4d__geglu_ffn__prompt_kernel_nosig_21
    s_lshl_b32 s26, s20, 11
    s_lshl_b32 s27, s21, 2
    s_add_u32 s26, s26, s27
    v_mov_b32 v2, 1
    v_lshlrev_b32 v5, 7, v1
    s_mov_b64 s[48:49], exec
    s_mov_b64 exec, 0xffff
    buffer_store_dword v2, v5, s[64:67], s26 offen sc1
    s_mov_b64 exec, s[48:49]
sequential_preLN__ssm_conv_s4d__geglu_ffn__prompt_kernel_nosig_21:
    s_mov_b32 s96, 0
    v_min_u32 v27, 13, v1
    v_lshlrev_b32 v27, 2, v27
    s_cmp_lg_u32 s18, 0
    s_cbranch_scc1 sequential_preLN__ssm_conv_s4d__geglu_ffn__prompt_kernel_pp_22
    s_cmp_eq_u32 s96, 1
    s_cbranch_scc1 sequential_preLN__ssm_conv_s4d__geglu_ffn__prompt_kernel_pp_22
    buffer_load_dword v24, v27, s[64:67], s95 offen sc1
sequential_preLN__ssm_conv_s4d__geglu_ffn__prompt_kernel_pp_22:
    s_add_u32 s14, s14, 4096
    s_add_u32 s15, s15, 4096
    buffer_load_dwordx4 a[192:195], v3, s[56:59], s14 offen offset:0 sc1
    buffer_load_dwordx4 a[196:199], v3, s[56:59], s15 offen offset:0 sc1
    buffer_load_dwordx4 a[200:203], v3, s[56:59], s14 offen offset:1024 sc1
    buffer_load_dwordx4 a[204:207], v3, s[56:59], s15 offen offset:1024 sc1
    s_cmp_lg_u32 s18, 0
    s_cbranch_scc1 sequential_preLN__ssm_conv_s4d__geglu_ffn__prompt_kernel_pp_23
    s_cmp_eq_u32 s96, 1
    s_cbranch_scc1 sequential_preLN__ssm_conv_s4d__geglu_ffn__prompt_kernel_pp_23
    buffer_load_dword v25, v27, s[64:67], s95 offen sc1
sequential_preLN__ssm_conv_s4d__geglu_ffn__prompt_kernel_pp_23:
    buffer_load_dwordx4 a[208:211], v3, s[56:59], s14 offen offset:2048 sc1
    buffer_load_dwordx4 a[212:215], v3, s[56:59], s15 offen offset:2048 sc1
    buffer_load_dwordx4 a[216:219], v3, s[56:59], s14 offen offset:3072 sc1
    buffer_load_dwordx4 a[220:223], v3, s[56:59], s15 offen offset:3072 sc1
    s_branch sequential_preLN__ssm_conv_s4d__geglu_ffn__prompt_kernel_f_gemm2
sequential_preLN__ssm_conv_s4d__geglu_ffn__prompt_kernel_slow4_17:
    s_mov_b32 s55, 1048576
sequential_preLN__ssm_conv_s4d__geglu_ffn__prompt_kernel_f4l_24:
    buffer_load_dwordx4 v[92:95], v3, s[60:63], s99 offen sc1
    s_waitcnt vmcnt(0)
    v_cmp_eq_u32 vcc, s98, v92
    v_cmp_eq_u32 s[48:49], s98, v93
    s_nop 3
    s_and_b64 vcc, vcc, s[48:49]
    v_cmp_eq_u32 s[48:49], s98, v94
    s_nop 3
    s_and_b64 vcc, vcc, s[48:49]
    v_cmp_eq_u32 s[48:49], s98, v95
    s_nop 3
    s_and_b64 vcc, vcc, s[48:49]
    s_cmp_eq_u64 vcc, exec
    s_cbranch_scc1 sequential_preLN__ssm_conv_s4d__geglu_ffn__prompt_kernel_f4d_25
    s_sub_u32 s55, s55, 1
    s_cmp_lg_u32 s55, 0
    s_cbranch_scc1 sequential_preLN__ssm_conv_s4d__geglu_ffn__prompt_kernel_f4l_24
sequential_preLN__ssm_conv_s4d__geglu_ffn__prompt_kernel_f4d_25:
    s_branch sequential_preLN__ssm_conv_s4d__geglu_ffn__prompt_kernel_back4_18
sequential_preLN__ssm_conv_s4d__geglu_ffn__prompt_kernel_slow_19:
    s_mov_b32 s55, 1048576
sequential_preLN__ssm_conv_s4d__geglu_ffn__prompt_kernel_poll_26:
    buffer_load_dword v28, v4, s[64:67], s51 offen sc1
    s_waitcnt vmcnt(0)
    v_readfirstlane_b32 s54, v28
    s_nop 3
    s_cmp_ge_u32 s54, 2
    s_cbranch_scc1 sequential_preLN__ssm_conv_s4d__geglu_ffn__prompt_kernel_polled_27
    s_sub_u32 s55, s55, 1
    s_cmp_lg_u32 s55, 0
    s_cbranch_scc1 sequential_preLN__ssm_conv_s4d__geglu_ffn__prompt_kernel_poll_26
sequential_preLN__ssm_conv_s4d__geglu_ffn__prompt_kernel_polled_27:
    s_branch sequential_preLN__ssm_conv_s4d__geglu_ffn__prompt_kernel_back_20
sequential_preLN__ssm_conv_s4d__geglu_ffn__prompt_kernel_f_helper:
    s_add_u32 s40, s8, 0xfd0000
    s_addc_u32 s41, s9, 0
    s_mov_b32 s42, 0x10000
    s_mov_b32 s43, 0x20000
    s_cmp_lg_u32 s18, 0
    s_cbranch_scc1 sequential_preLN__ssm_conv_s4d__geglu_ffn__prompt_kernel_f3w_28
    s_and_b32 s26, s2, 7
    s_lshr_b32 s27, s2, 5
    s_lshl_b32 s27, s27, 3
    s_add_u32 s26, s26, s27
    s_lshl_b32 s26, s26, 10
    v_lshlrev_b32 v13, 4, v1
    s_mov_b32 s55, 1048576
sequential_preLN__ssm_conv_s4d__geglu_ffn__prompt_kernel_f3l_29:
    buffer_load_dwordx4 v[16:19], v13, s[40:43], s26 offen sc1
    s_waitcnt vmcnt(0)
    v_cmp_eq_u32 vcc, s98, v16
    v_cmp_eq_u32 s[50:51], s98, v17
    s_nop 3
    s_and_b64 vcc, vcc, s[50:51]
    v_cmp_eq_u32 s[50:51], s98, v18
    s_nop 3
    s_and_b64 vcc, vcc, s[50:51]
    v_cmp_eq_u32 s[50:51], s98, v19
    s_nop 3
    s_and_b64 vcc, vcc, s[50:51]
    s_cmp_eq_u64 vcc, exec
    s_cbranch_scc1 sequential_preLN__ssm_conv_s4d__geglu_ffn__prompt_kernel_f3w_28
    s_sub_u32 s55, s55, 1
    s_cmp_lg_u32 s55, 0
    s_cbranch_scc1 sequential_preLN__ssm_conv_s4d__geglu_ffn__prompt_kernel_f3l_29
sequential_preLN__ssm_conv_s4d__geglu_ffn__prompt_kernel_f3w_28:
    s_waitcnt vmcnt(0)
    s_barrier
    s_cmp_lg_u32 s18, 0
    s_cbranch_scc1 sequential_preLN__ssm_conv_s4d__geglu_ffn__prompt_kernel_nosig4_30
    s_add_u32 s40, s8, 0xfe0000
    s_addc_u32 s41, s9, 0
    s_mov_b32 s42, 0x10000
    s_mov_b32 s43, 0x20000
    v_mov_b32 v16, s98
    v_lshlrev_b32 v17, 10, v1
    s_lshl_b32 s26, s2, 2
    buffer_store_dword v16, v17, s[40:43], s26 offen sc1
sequential_preLN__ssm_conv_s4d__geglu_ffn__prompt_kernel_nosig4_30:
    s_cmp_lg_u32 s2, 0
    s_cbranch_scc1 sequential_preLN__ssm_conv_s4d__geglu_ffn__prompt_kernel_notok_31
    s_cmp_lg_u32 s18, 0
    s_cbranch_scc1 sequential_preLN__ssm_conv_s4d__geglu_ffn__prompt_kernel_notok_31
    s_add_u32 s40, s8, 0xfc0000
    s_addc_u32 s41, s9, 0
    s_mov_b32 s42, 0x4
    s_mov_b32 s43, 0x20000
    v_mov_b32 v16, s98
    v_mov_b32 v17, 0
    buffer_store_dword v16, v17, s[40:43], 0 offen sc1
sequential_preLN__ssm_conv_s4d__geglu_ffn__prompt_kernel_notok_31:
    s_add_u32 s40, s8, 0x7c0000
    s_addc_u32 s41, s9, 0
    s_mov_b32 s42, 0xe000
    s_mov_b32 s43, 0x20000
    s_add_u32 s44, s8, 0x800000
    s_addc_u32 s45, s9, 0
    s_mov_b32 s46, 0x700000
    s_mov_b32 s47, 0x20000
    s_add_u32 s56, s8, 0x600000
    s_addc_u32 s57, s9, 0
    s_mov_b32 s58, 0x1c0000
    s_mov_b32 s59, 0x20000
    s_add_u32 s60, s8, 0x7d0000
    s_addc_u32 s61, s9, 0
    s_mov_b32 s62, 0x8000
    s_mov_b32 s63, 0x20000
    s_add_u32 s64, s8, 0xf80000
    s_addc_u32 s65, s9, 0
    s_mov_b32 s66, 0x9000
    s_mov_b32 s67, 0x20000
    s_mov_b32 s68, s10
    s_mov_b32 s69, s11
    s_mov_b32 s70, 0x200000
    s_mov_b32 s71, 0x20000
    s_mul_i32 s14, s18, 28
    s_lshl_b32 s15, s13, 1
    s_mul_i32 s15, s15, 112
    s_add_u32 s14, s15, s14
    s_lshl_b32 s14, s14, 10
    s_add_u32 s15, s14, 114688
    v_lshlrev_b32 v3, 4, v1
    v_mov_b32 v4, 0
    s_lshr_b32 s95, s12, 1
    s_lshl_b32 s95, s95, 4
    s_and_b32 s26, s22, 15
    s_add_u32 s95, s95, s26
    s_lshl_b32 s95, s95, 7
    s_mov_b32 s93, 0
    s_lshl_b32 s26, s93, 12
    s_add_u32 s14, s14, s26
    s_add_u32 s15, s15, s26
    s_mov_b32 s94, s93
    v_and_b32 v5, 7, v0
    v_lshrrev_b32 v6, 3, v0
    v_lshlrev_b32 v7, 12, v6
    v_lshl_add_u32 v7, v5, 4, v7
    s_lshl_b32 s26, s20, 8
    s_lshl_b32 s27, s19, 7
    s_add_u32 s26, s26, s27
    v_add_u32 v7, s26, v7
    s_mov_b32 s27, 0x0
    buffer_load_dwordx4 v[64:67], v7, s[36:39], s27 offen sc1
    s_mov_b32 s27, 0x20000
    buffer_load_dwordx4 v[68:71], v7, s[36:39], s27 offen sc1
    s_mov_b32 s27, 0x40000
    buffer_load_dwordx4 v[72:75], v7, s[36:39], s27 offen sc1
    s_mov_b32 s27, 0x60000
    buffer_load_dwordx4 v[76:79], v7, s[36:39], s27 offen sc1
    s_mov_b32 s27, 0x80000
    buffer_load_dwordx4 v[80:83], v7, s[36:39], s27 offen sc1
    s_mov_b32 s27, 0xa0000
    buffer_load_dwordx4 v[84:87], v7, s[36:39], s27 offen sc1
    s_mov_b32 s27, 0xc0000
    buffer_load_dwordx4 v[88:91], v7, s[36:39], s27 offen sc1
    s_mov_b32 s27, 0xe0000
    buffer_load_dwordx4 v[92:95], v7, s[36:39], s27 offen sc1
    s_mov_b32 s27, 0x100000
    buffer_load_dwordx4 v[96:99], v7, s[36:39], s27 offen sc1
    s_mov_b32 s27, 0x120000
    buffer_load_dwordx4 v[100:103], v7, s[36:39], s27 offen sc1
    s_mov_b32 s27, 0x140000
    buffer_load_dwordx4 v[104:107], v7, s[36:39], s27 offen sc1
    s_mov_b32 s27, 0x160000
    buffer_load_dwordx4 v[108:111], v7, s[36:39], s27 offen sc1
    s_mov_b32 s27, 0x180000
    buffer_load_dwordx4 v[112:115], v7, s[36:39], s27 offen sc1
    s_mov_b32 s27, 0x1a0000
    buffer_load_dwordx4 v[116:119], v7, s[36:39], s27 offen sc1
    s_mov_b32 s27, 0x1c0000
    buffer_load_dwordx4 v[120:123], v7, s[36:39], s27 offen sc1
    s_mov_b32 s27, 0x1e0000
    buffer_load_dwordx4 v[124:127], v7, s[36:39], s27 offen sc1
    s_mov_b32 s48, 0xffff0000
    v_mov_b32 v32, 0
    v_mov_b32 v33, 0
    v_mov_b32 v34, 0
    v_mov_b32 v35, 0
    v_mov_b32 v36, 0
    v_mov_b32 v37, 0
    v_mov_b32 v38, 0
    v_mov_b32 v39, 0
    v_mov_b32 v40, 0
    v_mov_b32 v41, 0
    v_mov_b32 v42, 0
    v_mov_b32 v43, 0
    v_mov_b32 v44, 0
    v_mov_b32 v45, 0
    v_mov_b32 v46, 0
    v_mov_b32 v47, 0
    s_waitcnt vmcnt(15)
    v_lshlrev_b32 v48, 16, v64
    v_lshlrev_b32 v50, 16, v65
    v_lshlrev_b32 v52, 16, v66
    v_lshlrev_b32 v54, 16, v67
    v_and_b32 v49, s48, v64
    v_and_b32 v51, s48, v65
    v_and_b32 v53, s48, v66
    v_and_b32 v55, s48, v67
    v_pk_add_f32 v[32:33], v[32:33], v[48:49]
    v_pk_add_f32 v[34:35], v[34:35], v[50:51]
    v_pk_add_f32 v[36:37], v[36:37], v[52:53]
    v_pk_add_f32 v[38:39], v[38:39], v[54:55]
    v_pk_fma_f32 v[40:41], v[48:49], v[48:49], v[40:41]
    v_pk_fma_f32 v[42:43], v[50:51], v[50:51], v[42:43]
    v_pk_fma_f32 v[44:45], v[52:53], v[52:53], v[44:45]
    v_pk_fma_f32 v[46:47], v[54:55], v[54:55], v[46:47]
    s_waitcnt vmcnt(14)
    v_lshlrev_b32 v48, 16, v68
    v_lshlrev_b32 v50, 16, v69
    v_lshlrev_b32 v52, 16, v70
    v_lshlrev_b32 v54, 16, v71
    v_and_b32 v49, s48, v68
    v_and_b32 v51, s48, v69
    v_and_b32 v53, s48, v70
    v_and_b32 v55, s48, v71
    v_pk_add_f32 v[32:33], v[32:33], v[48:49]
    v_pk_add_f32 v[34:35], v[34:35], v[50:51]
    v_pk_add_f32 v[36:37], v[36:37], v[52:53]
    v_pk_add_f32 v[38:39], v[38:39], v[54:55]
    v_pk_fma_f32 v[40:41], v[48:49], v[48:49], v[40:41]
    v_pk_fma_f32 v[42:43], v[50:51], v[50:51], v[42:43]
    v_pk_fma_f32 v[44:45], v[52:53], v[52:53], v[44:45]
    v_pk_fma_f32 v[46:47], v[54:55], v[54:55], v[46:47]
    s_waitcnt vmcnt(13)
    v_lshlrev_b32 v48, 16, v72
    v_lshlrev_b32 v50, 16, v73
    v_lshlrev_b32 v52, 16, v74
    v_lshlrev_b32 v54, 16, v75
    v_and_b32 v49, s48, v72
    v_and_b32 v51, s48, v73
    v_and_b32 v53, s48, v74
    v_and_b32 v55, s48, v75
    v_pk_add_f32 v[32:33], v[32:33], v[48:49]
    v_pk_add_f32 v[34:35], v[34:35], v[50:51]
    v_pk_add_f32 v[36:37], v[36:37], v[52:53]
    v_pk_add_f32 v[38:39], v[38:39], v[54:55]
    v_pk_fma_f32 v[40:41], v[48:49], v[48:49], v[40:41]
    v_pk_fma_f32 v[42:43], v[50:51], v[50:51], v[42:43]
    v_pk_fma_f32 v[44:45], v[52:53], v[52:53], v[44:45]
    v_pk_fma_f32 v[46:47], v[54:55], v[54:55], v[46:47]
    s_waitcnt vmcnt(12)
    v_lshlrev_b32 v48, 16, v76
    v_lshlrev_b32 v50, 16, v77
    v_lshlrev_b32 v52, 16, v78
    v_lshlrev_b32 v54, 16, v79
    v_and_b32 v49, s48, v76
    v_and_b32 v51, s48, v77
    v_and_b32 v53, s48, v78
    v_and_b32 v55, s48, v79
    v_pk_add_f32 v[32:33], v[32:33], v[48:49]
    v_pk_add_f32 v[34:35], v[34:35], v[50:51]
    v_pk_add_f32 v[36:37], v[36:37], v[52:53]
    v_pk_add_f32 v[38:39], v[38:39], v[54:55]
    v_pk_fma_f32 v[40:41], v[48:49], v[48:49], v[40:41]
    v_pk_fma_f32 v[42:43], v[50:51], v[50:51], v[42:43]
    v_pk_fma_f32 v[44:45], v[52:53], v[52:53], v[44:45]
    v_pk_fma_f32 v[46:47], v[54:55], v[54:55], v[46:47]
    s_waitcnt vmcnt(11)
    v_lshlrev_b32 v48, 16, v80
    v_lshlrev_b32 v50, 16, v81
    v_lshlrev_b32 v52, 16, v82
    v_lshlrev_b32 v54, 16, v83
    v_and_b32 v49, s48, v80
    v_and_b32 v51, s48, v81
    v_and_b32 v53, s48, v82
    v_and_b32 v55, s48, v83
    v_pk_add_f32 v[32:33], v[32:33], v[48:49]
    v_pk_add_f32 v[34:35], v[34:35], v[50:51]
    v_pk_add_f32 v[36:37], v[36:37], v[52:53]
    v_pk_add_f32 v[38:39], v[38:39], v[54:55]
    v_pk_fma_f32 v[40:41], v[48:49], v[48:49], v[40:41]
    v_pk_fma_f32 v[42:43], v[50:51], v[50:51], v[42:43]
    v_pk_fma_f32 v[44:45], v[52:53], v[52:53], v[44:45]
    v_pk_fma_f32 v[46:47], v[54:55], v[54:55], v[46:47]
    s_waitcnt vmcnt(10)
    v_lshlrev_b32 v48, 16, v84
    v_lshlrev_b32 v50, 16, v85
    v_lshlrev_b32 v52, 16, v86
    v_lshlrev_b32 v54, 16, v87
    v_and_b32 v49, s48, v84
    v_and_b32 v51, s48, v85
    v_and_b32 v53, s48, v86
    v_and_b32 v55, s48, v87
    v_pk_add_f32 v[32:33], v[32:33], v[48:49]
    v_pk_add_f32 v[34:35], v[34:35], v[50:51]
    v_pk_add_f32 v[36:37], v[36:37], v[52:53]
    v_pk_add_f32 v[38:39], v[38:39], v[54:55]
    v_pk_fma_f32 v[40:41], v[48:49], v[48:49], v[40:41]
    v_pk_fma_f32 v[42:43], v[50:51], v[50:51], v[42:43]
    v_pk_fma_f32 v[44:45], v[52:53], v[52:53], v[44:45]
    v_pk_fma_f32 v[46:47], v[54:55], v[54:55], v[46:47]
    s_waitcnt vmcnt(9)
    v_lshlrev_b32 v48, 16, v88
    v_lshlrev_b32 v50, 16, v89
    v_lshlrev_b32 v52, 16, v90
    v_lshlrev_b32 v54, 16, v91
    v_and_b32 v49, s48, v88
    v_and_b32 v51, s48, v89
    v_and_b32 v53, s48, v90
    v_and_b32 v55, s48, v91
    v_pk_add_f32 v[32:33], v[32:33], v[48:49]
    v_pk_add_f32 v[34:35], v[34:35], v[50:51]
    v_pk_add_f32 v[36:37], v[36:37], v[52:53]
    v_pk_add_f32 v[38:39], v[38:39], v[54:55]
    v_pk_fma_f32 v[40:41], v[48:49], v[48:49], v[40:41]
    v_pk_fma_f32 v[42:43], v[50:51], v[50:51], v[42:43]
    v_pk_fma_f32 v[44:45], v[52:53], v[52:53], v[44:45]
    v_pk_fma_f32 v[46:47], v[54:55], v[54:55], v[46:47]
    s_waitcnt vmcnt(8)
    v_lshlrev_b32 v48, 16, v92
    v_lshlrev_b32 v50, 16, v93
    v_lshlrev_b32 v52, 16, v94
    v_lshlrev_b32 v54, 16, v95
    v_and_b32 v49, s48, v92
    v_and_b32 v51, s48, v93
    v_and_b32 v53, s48, v94
    v_and_b32 v55, s48, v95
    v_pk_add_f32 v[32:33], v[32:33], v[48:49]
    v_pk_add_f32 v[34:35], v[34:35], v[50:51]
    v_pk_add_f32 v[36:37], v[36:37], v[52:53]
    v_pk_add_f32 v[38:39], v[38:39], v[54:55]
    v_pk_fma_f32 v[40:41], v[48:49], v[48:49], v[40:41]
    v_pk_fma_f32 v[42:43], v[50:51], v[50:51], v[42:43]
    v_pk_fma_f32 v[44:45], v[52:53], v[52:53], v[44:45]
    v_pk_fma_f32 v[46:47], v[54:55], v[54:55], v[46:47]
    s_waitcnt vmcnt(7)
    v_lshlrev_b32 v48, 16, v96
    v_lshlrev_b32 v50, 16, v97
    v_lshlrev_b32 v52, 16, v98
    v_lshlrev_b32 v54, 16, v99
    v_and_b32 v49, s48, v96
    v_and_b32 v51, s48, v97
    v_and_b32 v53, s48, v98
    v_and_b32 v55, s48, v99
    v_pk_add_f32 v[32:33], v[32:33], v[48:49]
    v_pk_add_f32 v[34:35], v[34:35], v[50:51]
    v_pk_add_f32 v[36:37], v[36:37], v[52:53]
    v_pk_add_f32 v[38:39], v[38:39], v[54:55]
    v_pk_fma_f32 v[40:41], v[48:49], v[48:49], v[40:41]
    v_pk_fma_f32 v[42:43], v[50:51], v[50:51], v[42:43]
    v_pk_fma_f32 v[44:45], v[52:53], v[52:53], v[44:45]
    v_pk_fma_f32 v[46:47], v[54:55], v[54:55], v[46:47]
    s_waitcnt vmcnt(6)
    v_lshlrev_b32 v48, 16, v100
    v_lshlrev_b32 v50, 16, v101
    v_lshlrev_b32 v52, 16, v102
    v_lshlrev_b32 v54, 16, v103
    v_and_b32 v49, s48, v100
    v_and_b32 v51, s48, v101
    v_and_b32 v53, s48, v102
    v_and_b32 v55, s48, v103
    v_pk_add_f32 v[32:33], v[32:33], v[48:49]
    v_pk_add_f32 v[34:35], v[34:35], v[50:51]
    v_pk_add_f32 v[36:37], v[36:37], v[52:53]
    v_pk_add_f32 v[38:39], v[38:39], v[54:55]
    v_pk_fma_f32 v[40:41], v[48:49], v[48:49], v[40:41]
    v_pk_fma_f32 v[42:43], v[50:51], v[50:51], v[42:43]
    v_pk_fma_f32 v[44:45], v[52:53], v[52:53], v[44:45]
    v_pk_fma_f32 v[46:47], v[54:55], v[54:55], v[46:47]
    s_waitcnt vmcnt(5)
    v_lshlrev_b32 v48, 16, v104
    v_lshlrev_b32 v50, 16, v105
    v_lshlrev_b32 v52, 16, v106
    v_lshlrev_b32 v54, 16, v107
    v_and_b32 v49, s48, v104
    v_and_b32 v51, s48, v105
    v_and_b32 v53, s48, v106
    v_and_b32 v55, s48, v107
    v_pk_add_f32 v[32:33], v[32:33], v[48:49]
    v_pk_add_f32 v[34:35], v[34:35], v[50:51]
    v_pk_add_f32 v[36:37], v[36:37], v[52:53]
    v_pk_add_f32 v[38:39], v[38:39], v[54:55]
    v_pk_fma_f32 v[40:41], v[48:49], v[48:49], v[40:41]
    v_pk_fma_f32 v[42:43], v[50:51], v[50:51], v[42:43]
    v_pk_fma_f32 v[44:45], v[52:53], v[52:53], v[44:45]
    v_pk_fma_f32 v[46:47], v[54:55], v[54:55], v[46:47]
    s_waitcnt vmcnt(4)
    v_lshlrev_b32 v48, 16, v108
    v_lshlrev_b32 v50, 16, v109
    v_lshlrev_b32 v52, 16, v110
    v_lshlrev_b32 v54, 16, v111
    v_and_b32 v49, s48, v108
    v_and_b32 v51, s48, v109
    v_and_b32 v53, s48, v110
    v_and_b32 v55, s48, v111
    v_pk_add_f32 v[32:33], v[32:33], v[48:49]
    v_pk_add_f32 v[34:35], v[34:35], v[50:51]
    v_pk_add_f32 v[36:37], v[36:37], v[52:53]
    v_pk_add_f32 v[38:39], v[38:39], v[54:55]
    v_pk_fma_f32 v[40:41], v[48:49], v[48:49], v[40:41]
    v_pk_fma_f32 v[42:43], v[50:51], v[50:51], v[42:43]
    v_pk_fma_f32 v[44:45], v[52:53], v[52:53], v[44:45]
    v_pk_fma_f32 v[46:47], v[54:55], v[54:55], v[46:47]
    s_waitcnt vmcnt(3)
    v_lshlrev_b32 v48, 16, v112
    v_lshlrev_b32 v50, 16, v113
    v_lshlrev_b32 v52, 16, v114
    v_lshlrev_b32 v54, 16, v115
    v_and_b32 v49, s48, v112
    v_and_b32 v51, s48, v113
    v_and_b32 v53, s48, v114
    v_and_b32 v55, s48, v115
    v_pk_add_f32 v[32:33], v[32:33], v[48:49]
    v_pk_add_f32 v[34:35], v[34:35], v[50:51]
    v_pk_add_f32 v[36:37], v[36:37], v[52:53]
    v_pk_add_f32 v[38:39], v[38:39], v[54:55]
    v_pk_fma_f32 v[40:41], v[48:49], v[48:49], v[40:41]
    v_pk_fma_f32 v[42:43], v[50:51], v[50:51], v[42:43]
    v_pk_fma_f32 v[44:45], v[52:53], v[52:53], v[44:45]
    v_pk_fma_f32 v[46:47], v[54:55], v[54:55], v[46:47]
    s_waitcnt vmcnt(2)
    v_lshlrev_b32 v48, 16, v116
    v_lshlrev_b32 v50, 16, v117
    v_lshlrev_b32 v52, 16, v118
    v_lshlrev_b32 v54, 16, v119
    v_and_b32 v49, s48, v116
    v_and_b32 v51, s48, v117
    v_and_b32 v53, s48, v118
    v_and_b32 v55, s48, v119
    v_pk_add_f32 v[32:33], v[32:33], v[48:49]
    v_pk_add_f32 v[34:35], v[34:35], v[50:51]
    v_pk_add_f32 v[36:37], v[36:37], v[52:53]
    v_pk_add_f32 v[38:39], v[38:39], v[54:55]
    v_pk_fma_f32 v[40:41], v[48:49], v[48:49], v[40:41]
    v_pk_fma_f32 v[42:43], v[50:51], v[50:51], v[42:43]
    v_pk_fma_f32 v[44:45], v[52:53], v[52:53], v[44:45]
    v_pk_fma_f32 v[46:47], v[54:55], v[54:55], v[46:47]
    s_waitcnt vmcnt(1)
    v_lshlrev_b32 v48, 16, v120
    v_lshlrev_b32 v50, 16, v121
    v_lshlrev_b32 v52, 16, v122
    v_lshlrev_b32 v54, 16, v123
    v_and_b32 v49, s48, v120
    v_and_b32 v51, s48, v121
    v_and_b32 v53, s48, v122
    v_and_b32 v55, s48, v123
    v_pk_add_f32 v[32:33], v[32:33], v[48:49]
    v_pk_add_f32 v[34:35], v[34:35], v[50:51]
    v_pk_add_f32 v[36:37], v[36:37], v[52:53]
    v_pk_add_f32 v[38:39], v[38:39], v[54:55]
    v_pk_fma_f32 v[40:41], v[48:49], v[48:49], v[40:41]
    v_pk_fma_f32 v[42:43], v[50:51], v[50:51], v[42:43]
    v_pk_fma_f32 v[44:45], v[52:53], v[52:53], v[44:45]
    v_pk_fma_f32 v[46:47], v[54:55], v[54:55], v[46:47]
    s_waitcnt vmcnt(0)
    v_lshlrev_b32 v48, 16, v124
    v_lshlrev_b32 v50, 16, v125
    v_lshlrev_b32 v52, 16, v126
    v_lshlrev_b32 v54, 16, v127
    v_and_b32 v49, s48, v124
    v_and_b32 v51, s48, v125
    v_and_b32 v53, s48, v126
    v_and_b32 v55, s48, v127
    v_pk_add_f32 v[32:33], v[32:33], v[48:49]
    v_pk_add_f32 v[34:35], v[34:35], v[50:51]
    v_pk_add_f32 v[36:37], v[36:37], v[52:53]
    v_pk_add_f32 v[38:39], v[38:39], v[54:55]
    v_pk_fma_f32 v[40:41], v[48:49], v[48:49], v[40:41]
    v_pk_fma_f32 v[42:43], v[50:51], v[50:51], v[42:43]
    v_pk_fma_f32 v[44:45], v[52:53], v[52:53], v[44:45]
    v_pk_fma_f32 v[46:47], v[54:55], v[54:55], v[46:47]
    v_mul_u32_u24 v10, 2304, v5
    v_lshl_add_u32 v10, v6, 2, v10
    ds_write_b32 v10, v32 offset:0
    ds_write_b32 v10, v40 offset:144
    ds_write_b32 v10, v33 offset:288
    ds_write_b32 v10, v41 offset:432
    ds_write_b32 v10, v34 offset:576
    ds_write_b32 v10, v42 offset:720
    ds_write_b32 v10, v35 offset:864
    ds_write_b32 v10, v43 offset:1008
    ds_write_b32 v10, v36 offset:1152
    ds_write_b32 v10, v44 offset:1296
    ds_write_b32 v10, v37 offset:1440
    s_waitcnt lgkmcnt(4)
    ds_write_b32 v10, v45 offset:1584
    ds_write_b32 v10, v38 offset:1728
    ds_write_b32 v10, v46 offset:1872
    ds_write_b32 v10, v39 offset:2016
    ds_write_b32 v10, v47 offset:2160
    s_waitcnt lgkmcnt(0)
    s_barrier
    s_cmp_ge_u32 s18, 2
    s_cbranch_scc1 sequential_preLN__ssm_conv_s4d__geglu_ffn__prompt_kernel_nostat_32
    v_mul_u32_u24 v10, 144, v0
    ds_read_b128 v[48:51], v10 offset:0
    ds_read_b128 v[52:55], v10 offset:16
    ds_read_b128 v[56:59], v10 offset:32
    ds_read_b128 v[60:63], v10 offset:48
    ds_read_b128 v[64:67], v10 offset:64
    ds_read_b128 v[68:71], v10 offset:80
    ds_read_b128 v[72:75], v10 offset:96
    ds_read_b128 v[76:79], v10 offset:112
    s_waitcnt lgkmcnt(0)
    v_pk_add_f32 v[48:49], v[48:49], v[64:65]
    v_pk_add_f32 v[50:51], v[50:51], v[66:67]
    v_pk_add_f32 v[52:53], v[52:53], v[68:69]
    v_pk_add_f32 v[54:55], v[54:55], v[70:71]
    v_pk_add_f32 v[56:57], v[56:57], v[72:73]
    v_pk_add_f32 v[58:59], v[58:59], v[74:75]
    v_pk_add_f32 v[60:61], v[60:61], v[76:77]
    v_pk_add_f32 v[62:63], v[62:63], v[78:79]
    v_pk_add_f32 v[48:49], v[48:49], v[56:57]
    v_pk_add_f32 v[50:51], v[50:51], v[58:59]
    v_pk_add_f32 v[52:53], v[52:53], v[60:61]
    v_pk_add_f32 v[54:55], v[54:55], v[62:63]
    v_pk_add_f32 v[48:49], v[48:49], v[52:53]
    v_pk_add_f32 v[50:51], v[50:51], v[54:55]
    v_pk_add_f32 v[48:49], v[48:49], v[50:51]
    v_add_f32 v48, v48, v49
    v_mov_b32 v49, v48
    s_nop 1
    v_mov_b32_dpp v49, v48 quad_perm:[1,1,3,3] row_mask:0xf bank_mask:0xf
    v_mov_b32_dpp v50, v48 quad_perm:[0,0,2,2] row_mask:0xf bank_mask:0xf
    s_mov_b32 s26, 0x3b000000
    s_mov_b32 s27, 0x3727c5ac
    v_mul_f32 v50, s26, v50
    v_mul_f32 v49, s26, v49
    v_fma_f32 v49, -v50, v50, v49
    v_max_f32 v49, 0, v49
    v_cvt_pk_bf16_f32 v51, v50, v49
    v_lshlrev_b32 v50, 16, v51
    v_and_b32 v49, s48, v51
    v_sub_f32 v52, 0, v50
    v_add_f32 v49, s27, v49
    v_cvt_pk_bf16_f32 v49, v49, v49
    v_and_b32 v49, s48, v49
    v_sqrt_f32 v49, v49
    s_nop 0
    v_cvt_pk_bf16_f32 v49, v49, v49
    v_and_b32 v49, s48, v49
    v_rcp_f32 v50, v49
    v_mul_f32 v55, v49, v49
    s_mov_b32 s26, 0xc0135761
    s_mov_b32 s27, 0xbdd2d3e8
    v_mul_f32 v53, s26, v50
    v_mul_f32 v51, v50, v50
    v_mul_f32 v51, v51, v50
    v_mul_f32 v54, s27, v51
    v_lshrrev_b32 v10, 1, v0
    s_lshl_b32 s26, s20, 7
    s_lshl_b32 s27, s19, 6
    s_add_u32 s26, s26, s27
    v_add_u32 v10, s26, v10
    v_lshlrev_b32 v10, 4, v10
    buffer_store_dwordx4 v[52:55], v10, s[60:63], 0 offen sc1
sequential_preLN__ssm_conv_s4d__geglu_ffn__prompt_kernel_nostat_32:
    s_waitcnt vmcnt(0)
    s_barrier
    s_cmp_lg_u32 s18, 0
    s_cbranch_scc1 sequential_preLN__ssm_conv_s4d__geglu_ffn__prompt_kernel_nosig2_33
    v_mov_b32 v2, 1
    s_mov_b64 s[48:49], exec
    s_mov_b64 exec, 1
    s_lshl_b32 s26, s20, 7
    s_add_u32 s26, s26, 32768
    buffer_atomic_add v2, v4, s[64:67], s26 offen sc1
    s_mov_b64 exec, s[48:49]
sequential_preLN__ssm_conv_s4d__geglu_ffn__prompt_kernel_nosig2_33:
    s_mov_b32 s96, 0
    v_min_u32 v27, 13, v1
    v_lshlrev_b32 v27, 2, v27
    s_add_u32 s60, s8, 0xfe0000
    s_addc_u32 s61, s9, 0
    s_mov_b32 s62, 0x10000
    s_mov_b32 s63, 0x20000
    s_and_b32 s26, s2, 7
    s_lshr_b32 s27, s2, 5
    s_lshl_b32 s27, s27, 3
    s_add_u32 s26, s26, s27
    s_lshl_b32 s99, s26, 10
    s_mov_b32 s55, 1048576
sequential_preLN__ssm_conv_s4d__geglu_ffn__prompt_kernel_f4l_34:
    buffer_load_dwordx4 v[92:95], v3, s[60:63], s99 offen sc1
    s_waitcnt vmcnt(0)
    v_cmp_eq_u32 vcc, s98, v92
    v_cmp_eq_u32 s[48:49], s98, v93
    s_nop 3
    s_and_b64 vcc, vcc, s[48:49]
    v_cmp_eq_u32 s[48:49], s98, v94
    s_nop 3
    s_and_b64 vcc, vcc, s[48:49]
    v_cmp_eq_u32 s[48:49], s98, v95
    s_nop 3
    s_and_b64 vcc, vcc, s[48:49]
    s_cmp_eq_u64 vcc, exec
    s_cbranch_scc1 sequential_preLN__ssm_conv_s4d__geglu_ffn__prompt_kernel_f4d_35
    s_sub_u32 s55, s55, 1
    s_cmp_lg_u32 s55, 0
    s_cbranch_scc1 sequential_preLN__ssm_conv_s4d__geglu_ffn__prompt_kernel_f4l_34
sequential_preLN__ssm_conv_s4d__geglu_ffn__prompt_kernel_f4d_35:
    v_lshrrev_b32 v5, 3, v1
    v_and_b32 v6, 7, v1
    s_lshl_b32 s50, s13, 6
    s_lshl_b32 s52, s18, 4
    s_add_u32 s50, s50, s52
    v_add_u32 v7, s50, v5
    v_lshlrev_b32 v7, 12, v7
    v_lshl_add_u32 v7, v6, 4, v7
    s_lshl_b32 s50, s12, 7
    buffer_load_dwordx4 v[8:11], v7, s[36:39], s50 offen sc1
    s_add_u32 s50, s50, 32768
    buffer_load_dwordx4 v[12:15], v7, s[36:39], s50 offen sc1
    v_add_u32 v7, s52, v5
    v_mul_u32_u24 v7, 144, v7
    v_lshl_add_u32 v7, v6, 4, v7
    v_add_u32 v7, 69632, v7
    buffer_load_dwordx4 a[0:3], v3, s[56:59], s14 offen offset:0 sc1
    buffer_load_dwordx4 a[4:7], v3, s[56:59], s15 offen offset:0 sc1
    buffer_load_dwordx4 a[8:11], v3, s[56:59], s14 offen offset:1024 sc1
    buffer_load_dwordx4 a[12:15], v3, s[56:59], s15 offen offset:1024 sc1
    buffer_load_dwordx4 a[16:19], v3, s[56:59], s14 offen offset:2048 sc1
    buffer_load_dwordx4 a[20:23], v3, s[56:59], s15 offen offset:2048 sc1
    buffer_load_dwordx4 a[24:27], v3, s[56:59], s14 offen offset:3072 sc1
    buffer_load_dwordx4 a[28:31], v3, s[56:59], s15 offen offset:3072 sc1
    s_add_u32 s14, s14, 4096
    s_add_u32 s15, s15, 4096
    buffer_load_dwordx4 a[32:35], v3, s[56:59], s14 offen offset:0 sc1
    buffer_load_dwordx4 a[36:39], v3, s[56:59], s15 offen offset:0 sc1
    buffer_load_dwordx4 a[40:43], v3, s[56:59], s14 offen offset:1024 sc1
    buffer_load_dwordx4 a[44:47], v3, s[56:59], s15 offen offset:1024 sc1
    buffer_load_dwordx4 a[48:51], v3, s[56:59], s14 offen offset:2048 sc1
    buffer_load_dwordx4 a[52:55], v3, s[56:59], s15 offen offset:2048 sc1
    buffer_load_dwordx4 a[56:59], v3, s[56:59], s14 offen offset:3072 sc1
    buffer_load_dwordx4 a[60:63], v3, s[56:59], s15 offen offset:3072 sc1
    s_add_u32 s14, s14, 4096
    s_add_u32 s15, s15, 4096
    buffer_load_dwordx4 a[64:67], v3, s[56:59], s14 offen offset:0 sc1
    buffer_load_dwordx4 a[68:71], v3, s[56:59], s15 offen offset:0 sc1
    buffer_load_dwordx4 a[72:75], v3, s[56:59], s14 offen offset:1024 sc1
    buffer_load_dwordx4 a[76:79], v3, s[56:59], s15 offen offset:1024 sc1
    buffer_load_dwordx4 a[80:83], v3, s[56:59], s14 offen offset:2048 sc1
    buffer_load_dwordx4 a[84:87], v3, s[56:59], s15 offen offset:2048 sc1
    buffer_load_dwordx4 a[88:91], v3, s[56:59], s14 offen offset:3072 sc1
    buffer_load_dwordx4 a[92:95], v3, s[56:59], s15 offen offset:3072 sc1
    s_add_u32 s14, s14, 4096
    s_add_u32 s15, s15, 4096
    buffer_load_dwordx4 a[96:99], v3, s[56:59], s14 offen offset:0 sc1
    buffer_load_dwordx4 a[100:103], v3, s[56:59], s15 offen offset:0 sc1
    buffer_load_dwordx4 a[104:107], v3, s[56:59], s14 offen offset:1024 sc1
    buffer_load_dwordx4 a[108:111], v3, s[56:59], s15 offen offset:1024 sc1
    buffer_load_dwordx4 a[112:115], v3, s[56:59], s14 offen offset:2048 sc1
    buffer_load_dwordx4 a[116:119], v3, s[56:59], s15 offen offset:2048 sc1
    buffer_load_dwordx4 a[120:123], v3, s[56:59], s14 offen offset:3072 sc1
    buffer_load_dwordx4 a[124:127], v3, s[56:59], s15 offen offset:3072 sc1
    s_add_u32 s14, s14, 4096
    s_add_u32 s15, s15, 4096
    buffer_load_dwordx4 a[128:131], v3, s[56:59], s14 offen offset:0 sc1
    buffer_load_dwordx4 a[132:135], v3, s[56:59], s15 offen offset:0 sc1
    buffer_load_dwordx4 a[136:139], v3, s[56:59], s14 offen offset:1024 sc1
    buffer_load_dwordx4 a[140:143], v3, s[56:59], s15 offen offset:1024 sc1
    buffer_load_dwordx4 a[144:147], v3, s[56:59], s14 offen offset:2048 sc1
    buffer_load_dwordx4 a[148:151], v3, s[56:59], s15 offen offset:2048 sc1
    buffer_load_dwordx4 a[152:155], v3, s[56:59], s14 offen offset:3072 sc1
    buffer_load_dwordx4 a[156:159], v3, s[56:59], s15 offen offset:3072 sc1
    s_add_u32 s14, s14, 4096
    s_add_u32 s15, s15, 4096
    buffer_load_dwordx4 a[160:163], v3, s[56:59], s14 offen offset:0 sc1
    buffer_load_dwordx4 a[164:167], v3, s[56:59], s15 offen offset:0 sc1
    buffer_load_dwordx4 a[168:171], v3, s[56:59], s14 offen offset:1024 sc1
    buffer_load_dwordx4 a[172:175], v3, s[56:59], s15 offen offset:1024 sc1
    buffer_load_dwordx4 a[176:179], v3, s[56:59], s14 offen offset:2048 sc1
    buffer_load_dwordx4 a[180:183], v3, s[56:59], s15 offen offset:2048 sc1
    buffer_load_dwordx4 a[184:187], v3, s[56:59], s14 offen offset:3072 sc1
    buffer_load_dwordx4 a[188:191], v3, s[56:59], s15 offen offset:3072 sc1
    s_add_u32 s14, s14, 4096
    s_add_u32 s15, s15, 4096
    buffer_load_dwordx4 a[192:195], v3, s[56:59], s14 offen offset:0 sc1
    buffer_load_dwordx4 a[196:199], v3, s[56:59], s15 offen offset:0 sc1
    buffer_load_dwordx4 a[200:203], v3, s[56:59], s14 offen offset:1024 sc1
    buffer_load_dwordx4 a[204:207], v3, s[56:59], s15 offen offset:1024 sc1
    buffer_load_dwordx4 a[208:211], v3, s[56:59], s14 offen offset:2048 sc1
    buffer_load_dwordx4 a[212:215], v3, s[56:59], s15 offen offset:2048 sc1
    buffer_load_dwordx4 a[216:219], v3, s[56:59], s14 offen offset:3072 sc1
    buffer_load_dwordx4 a[220:223], v3, s[56:59], s15 offen offset:3072 sc1
sequential_preLN__ssm_conv_s4d__geglu_ffn__prompt_kernel_f_gemm2:
    s_mul_i32 s24, s18, 28
    s_lshl_b32 s25, s12, 1
    s_mul_i32 s25, s25, 112
    s_add_u32 s24, s24, s25
    s_lshl_b32 s24, s24, 10
    s_add_u32 s25, s24, 114688
    s_lshl_b32 s26, s93, 12
    s_add_u32 s24, s24, s26
    s_add_u32 s25, s25, s26
    s_cmp_lg_u32 s18, 0
    s_cbranch_scc1 sequential_preLN__ssm_conv_s4d__geglu_ffn__prompt_kernel_nowait_36
    s_cmp_eq_u32 s96, 1
    s_cbranch_scc1 sequential_preLN__ssm_conv_s4d__geglu_ffn__prompt_kernel_nowait_36
    s_mov_b32 s55, 1048576
sequential_preLN__ssm_conv_s4d__geglu_ffn__prompt_kernel_hpoll_37:
    buffer_load_dword v16, v27, s[64:67], s95 offen sc1
    s_waitcnt vmcnt(0)
    v_cmp_eq_u32 vcc, 1, v16
    s_nop 3
    s_cmp_eq_u64 vcc, exec
    s_cbranch_scc1 sequential_preLN__ssm_conv_s4d__geglu_ffn__prompt_kernel_nowait_36
    s_sub_u32 s55, s55, 1
    s_cmp_lg_u32 s55, 0
    s_cbranch_scc1 sequential_preLN__ssm_conv_s4d__geglu_ffn__prompt_kernel_hpoll_37
sequential_preLN__ssm_conv_s4d__geglu_ffn__prompt_kernel_nowait_36:
    s_waitcnt vmcnt(0)
    ds_write_b128 v7, v[8:11]
    ds_write_b128 v7, v[12:15] offset:1152
    s_barrier
    buffer_load_dwordx4 v[32:35], v3, s[44:47], s24 offen offset:0 sc1
    buffer_load_dwordx4 v[36:39], v3, s[44:47], s25 offen offset:0 sc1
    buffer_load_dwordx4 v[40:43], v3, s[44:47], s24 offen offset:1024 sc1
    buffer_load_dwordx4 v[44:47], v3, s[44:47], s25 offen offset:1024 sc1
    buffer_load_dwordx4 v[48:51], v3, s[44:47], s24 offen offset:2048 sc1
    buffer_load_dwordx4 v[52:55], v3, s[44:47], s25 offen offset:2048 sc1
    buffer_load_dwordx4 v[56:59], v3, s[44:47], s24 offen offset:3072 sc1
    buffer_load_dwordx4 v[60:63], v3, s[44:47], s25 offen offset:3072 sc1
    s_add_u32 s24, s24, 4096
    s_add_u32 s25, s25, 4096
    buffer_load_dwordx4 v[64:67], v3, s[44:47], s24 offen offset:0 sc1
    buffer_load_dwordx4 v[68:71], v3, s[44:47], s25 offen offset:0 sc1
    buffer_load_dwordx4 v[72:75], v3, s[44:47], s24 offen offset:1024 sc1
    buffer_load_dwordx4 v[76:79], v3, s[44:47], s25 offen offset:1024 sc1
    buffer_load_dwordx4 v[80:83], v3, s[44:47], s24 offen offset:2048 sc1
    buffer_load_dwordx4 v[84:87], v3, s[44:47], s25 offen offset:2048 sc1
    buffer_load_dwordx4 v[88:91], v3, s[44:47], s24 offen offset:3072 sc1
    buffer_load_dwordx4 v[92:95], v3, s[44:47], s25 offen offset:3072 sc1
    s_waitcnt lgkmcnt(0)
    v_and_b32 v28, 31, v1
    v_lshrrev_b32 v6, 5, v1
    v_mul_u32_u24 v28, 272, v28
    v_lshl_add_u32 v28, v6, 4, v28
    s_mul_i32 s50, s18, 17408
    v_add_u32 v28, s50, v28
    v_and_b32 v5, 15, v1
    v_lshrrev_b32 v6, 4, v1
    s_lshl_b32 s50, s18, 4
    v_add_u32 v29, s50, v5
    v_mul_u32_u24 v8, 272, v29
    v_lshl_add_u32 v8, v6, 5, v8
    v_bfe_u32 v9, v1, 2, 2
    v_lshl_add_u32 v9, v6, 3, v9
    v_mul_u32_u24 v9, 144, v9
    v_and_b32 v10, 3, v1
    v_lshl_add_u32 v9, v10, 3, v9
    s_lshl_b32 s50, s18, 5
    v_add_u32 v9, s50, v9
    v_add_u32 v9, 69632, v9
    s_lshl_b32 s50, s12, 6
    v_add_u32 v29, s50, v29
    v_lshlrev_b32 v29, 10, v29
    v_lshl_add_u32 v29, v6, 4, v29
    s_lshl_b32 s52, s13, 7
    s_mov_b32 s51, 0xffff0000
    s_waitcnt vmcnt(14)
    v_mfma_f32_32x32x16_bf16 v[128:143], a[0:3], v[32:35], 0
    v_mfma_f32_32x32x16_bf16 v[144:159], a[0:3], v[36:39], 0
    v_mfma_f32_32x32x16_bf16 v[160:175], a[4:7], v[32:35], 0
    v_mfma_f32_32x32x16_bf16 v[176:191], a[4:7], v[36:39], 0
    s_add_u32 s24, s24, 4096
    s_add_u32 s25, s25, 4096
    buffer_load_dwordx4 v[96:99], v3, s[44:47], s24 offen offset:0 sc1
    buffer_load_dwordx4 v[100:103], v3, s[44:47], s25 offen offset:0 sc1
    s_waitcnt vmcnt(14)
    v_mfma_f32_32x32x16_bf16 v[128:143], a[8:11], v[40:43], v[128:143]
    v_mfma_f32_32x32x16_bf16 v[144:159], a[8:11], v[44:47], v[144:159]
    v_mfma_f32_32x32x16_bf16 v[160:175], a[12:15], v[40:43], v[160:175]
    v_mfma_f32_32x32x16_bf16 v[176:191], a[12:15], v[44:47], v[176:191]
    buffer_load_dwordx4 v[104:107], v3, s[44:47], s24 offen offset:1024 sc1
    buffer_load_dwordx4 v[108:111], v3, s[44:47], s25 offen offset:1024 sc1
    s_waitcnt vmcnt(14)
    v_mfma_f32_32x32x16_bf16 v[128:143], a[16:19], v[48:51], v[128:143]
    v_mfma_f32_32x32x16_bf16 v[144:159], a[16:19], v[52:55], v[144:159]
    v_mfma_f32_32x32x16_bf16 v[160:175], a[20:23], v[48:51], v[160:175]
    v_mfma_f32_32x32x16_bf16 v[176:191], a[20:23], v[52:55], v[176:191]
    buffer_load_dwordx4 v[112:115], v3, s[44:47], s24 offen offset:2048 sc1
    buffer_load_dwordx4 v[116:119], v3, s[44:47], s25 offen offset:2048 sc1
    s_waitcnt vmcnt(14)
    v_mfma_f32_32x32x16_bf16 v[128:143], a[24:27], v[56:59], v[128:143]
    v_mfma_f32_32x32x16_bf16 v[144:159], a[24:27], v[60:63], v[144:159]
    v_mfma_f32_32x32x16_bf16 v[160:175], a[28:31], v[56:59], v[160:175]
    v_mfma_f32_32x32x16_bf16 v[176:191], a[28:31], v[60:63], v[176:191]
    buffer_load_dwordx4 v[120:123], v3, s[44:47], s24 offen offset:3072 sc1
    buffer_load_dwordx4 v[124:127], v3, s[44:47], s25 offen offset:3072 sc1
    s_waitcnt vmcnt(14)
    v_mfma_f32_32x32x16_bf16 v[128:143], a[32:35], v[64:67], v[128:143]
    v_mfma_f32_32x32x16_bf16 v[144:159], a[32:35], v[68:71], v[144:159]
    v_mfma_f32_32x32x16_bf16 v[160:175], a[36:39], v[64:67], v[160:175]
    v_mfma_f32_32x32x16_bf16 v[176:191], a[36:39], v[68:71], v[176:191]
    s_add_u32 s24, s24, 4096
    s_add_u32 s25, s25, 4096
    buffer_load_dwordx4 v[192:195], v3, s[44:47], s24 offen offset:0 sc1
    buffer_load_dwordx4 v[196:199], v3, s[44:47], s25 offen offset:0 sc1
    s_waitcnt vmcnt(14)
    v_mfma_f32_32x32x16_bf16 v[128:143], a[40:43], v[72:75], v[128:143]
    v_mfma_f32_32x32x16_bf16 v[144:159], a[40:43], v[76:79], v[144:159]
    v_mfma_f32_32x32x16_bf16 v[160:175], a[44:47], v[72:75], v[160:175]
    v_mfma_f32_32x32x16_bf16 v[176:191], a[44:47], v[76:79], v[176:191]
    buffer_load_dwordx4 v[200:203], v3, s[44:47], s24 offen offset:1024 sc1
    buffer_load_dwordx4 v[204:207], v3, s[44:47], s25 offen offset:1024 sc1
    s_waitcnt vmcnt(14)
    v_mfma_f32_32x32x16_bf16 v[128:143], a[48:51], v[80:83], v[128:143]
    v_mfma_f32_32x32x16_bf16 v[144:159], a[48:51], v[84:87], v[144:159]
    v_mfma_f32_32x32x16_bf16 v[160:175], a[52:55], v[80:83], v[160:175]
    v_mfma_f32_32x32x16_bf16 v[176:191], a[52:55], v[84:87], v[176:191]
    buffer_load_dwordx4 v[208:211], v3, s[44:47], s24 offen offset:2048 sc1
    buffer_load_dwordx4 v[212:215], v3, s[44:47], s25 offen offset:2048 sc1
    s_waitcnt vmcnt(14)
    v_mfma_f32_32x32x16_bf16 v[128:143], a[56:59], v[88:91], v[128:143]
    v_mfma_f32_32x32x16_bf16 v[144:159], a[56:59], v[92:95], v[144:159]
    v_mfma_f32_32x32x16_bf16 v[160:175], a[60:63], v[88:91], v[160:175]
    v_mfma_f32_32x32x16_bf16 v[176:191], a[60:63], v[92:95], v[176:191]
    buffer_load_dwordx4 v[216:219], v3, s[44:47], s24 offen offset:3072 sc1
    buffer_load_dwordx4 v[220:223], v3, s[44:47], s25 offen offset:3072 sc1
    s_waitcnt vmcnt(14)
    v_mfma_f32_32x32x16_bf16 v[128:143], a[64:67], v[96:99], v[128:143]
    v_mfma_f32_32x32x16_bf16 v[144:159], a[64:67], v[100:103], v[144:159]
    v_mfma_f32_32x32x16_bf16 v[160:175], a[68:71], v[96:99], v[160:175]
    v_mfma_f32_32x32x16_bf16 v[176:191], a[68:71], v[100:103], v[176:191]
    s_add_u32 s24, s24, 4096
    s_add_u32 s25, s25, 4096
    buffer_load_dwordx4 v[224:227], v3, s[44:47], s24 offen offset:0 sc1
    buffer_load_dwordx4 v[228:231], v3, s[44:47], s25 offen offset:0 sc1
    s_waitcnt vmcnt(14)
    v_mfma_f32_32x32x16_bf16 v[128:143], a[72:75], v[104:107], v[128:143]
    v_mfma_f32_32x32x16_bf16 v[144:159], a[72:75], v[108:111], v[144:159]
    v_mfma_f32_32x32x16_bf16 v[160:175], a[76:79], v[104:107], v[160:175]
    v_mfma_f32_32x32x16_bf16 v[176:191], a[76:79], v[108:111], v[176:191]
    buffer_load_dwordx4 v[232:235], v3, s[44:47], s24 offen offset:1024 sc1
    buffer_load_dwordx4 v[236:239], v3, s[44:47], s25 offen offset:1024 sc1
    s_waitcnt vmcnt(14)
    v_mfma_f32_32x32x16_bf16 v[128:143], a[80:83], v[112:115], v[128:143]
    v_mfma_f32_32x32x16_bf16 v[144:159], a[80:83], v[116:119], v[144:159]
    v_mfma_f32_32x32x16_bf16 v[160:175], a[84:87], v[112:115], v[160:175]
    v_mfma_f32_32x32x16_bf16 v[176:191], a[84:87], v[116:119], v[176:191]
    buffer_load_dwordx4 v[240:243], v3, s[44:47], s24 offen offset:2048 sc1
    buffer_load_dwordx4 v[244:247], v3, s[44:47], s25 offen offset:2048 sc1
    s_waitcnt vmcnt(14)
    v_mfma_f32_32x32x16_bf16 v[128:143], a[88:91], v[120:123], v[128:143]
    v_mfma_f32_32x32x16_bf16 v[144:159], a[88:91], v[124:127], v[144:159]
    v_mfma_f32_32x32x16_bf16 v[160:175], a[92:95], v[120:123], v[160:175]
    v_mfma_f32_32x32x16_bf16 v[176:191], a[92:95], v[124:127], v[176:191]
    buffer_load_dwordx4 v[248:251], v3, s[44:47], s24 offen offset:3072 sc1
    buffer_load_dwordx4 v[252:255], v3, s[44:47], s25 offen offset:3072 sc1
    s_waitcnt vmcnt(14)
    v_mfma_f32_32x32x16_bf16 v[128:143], a[96:99], v[192:195], v[128:143]
    v_mfma_f32_32x32x16_bf16 v[144:159], a[96:99], v[196:199], v[144:159]
    v_mfma_f32_32x32x16_bf16 v[160:175], a[100:103], v[192:195], v[160:175]
    v_mfma_f32_32x32x16_bf16 v[176:191], a[100:103], v[196:199], v[176:191]
    s_add_u32 s24, s24, 4096
    s_add_u32 s25, s25, 4096
    buffer_load_dwordx4 v[32:35], v3, s[44:47], s24 offen offset:0 sc1
    buffer_load_dwordx4 v[36:39], v3, s[44:47], s25 offen offset:0 sc1
    s_waitcnt vmcnt(14)
    v_mfma_f32_32x32x16_bf16 v[128:143], a[104:107], v[200:203], v[128:143]
    v_mfma_f32_32x32x16_bf16 v[144:159], a[104:107], v[204:207], v[144:159]
    v_mfma_f32_32x32x16_bf16 v[160:175], a[108:111], v[200:203], v[160:175]
    v_mfma_f32_32x32x16_bf16 v[176:191], a[108:111], v[204:207], v[176:191]
    buffer_load_dwordx4 v[40:43], v3, s[44:47], s24 offen offset:1024 sc1
    buffer_load_dwordx4 v[44:47], v3, s[44:47], s25 offen offset:1024 sc1
    s_waitcnt vmcnt(14)
    v_mfma_f32_32x32x16_bf16 v[128:143], a[112:115], v[208:211], v[128:143]
    v_mfma_f32_32x32x16_bf16 v[144:159], a[112:115], v[212:215], v[144:159]
    v_mfma_f32_32x32x16_bf16 v[160:175], a[116:119], v[208:211], v[160:175]
    v_mfma_f32_32x32x16_bf16 v[176:191], a[116:119], v[212:215], v[176:191]
    buffer_load_dwordx4 v[48:51], v3, s[44:47], s24 offen offset:2048 sc1
    buffer_load_dwordx4 v[52:55], v3, s[44:47], s25 offen offset:2048 sc1
    s_waitcnt vmcnt(14)
    v_mfma_f32_32x32x16_bf16 v[128:143], a[120:123], v[216:219], v[128:143]
    v_mfma_f32_32x32x16_bf16 v[144:159], a[120:123], v[220:223], v[144:159]
    v_mfma_f32_32x32x16_bf16 v[160:175], a[124:127], v[216:219], v[160:175]
    v_mfma_f32_32x32x16_bf16 v[176:191], a[124:127], v[220:223], v[176:191]
    buffer_load_dwordx4 v[56:59], v3, s[44:47], s24 offen offset:3072 sc1
    buffer_load_dwordx4 v[60:63], v3, s[44:47], s25 offen offset:3072 sc1
    s_waitcnt vmcnt(14)
    v_mfma_f32_32x32x16_bf16 v[128:143], a[128:131], v[224:227], v[128:143]
    v_mfma_f32_32x32x16_bf16 v[144:159], a[128:131], v[228:231], v[144:159]
    v_mfma_f32_32x32x16_bf16 v[160:175], a[132:135], v[224:227], v[160:175]
    v_mfma_f32_32x32x16_bf16 v[176:191], a[132:135], v[228:231], v[176:191]
    s_add_u32 s24, s24, 4096
    s_add_u32 s25, s25, 4096
    buffer_load_dwordx4 v[64:67], v3, s[44:47], s24 offen offset:0 sc1
    buffer_load_dwordx4 v[68:71], v3, s[44:47], s25 offen offset:0 sc1
    s_waitcnt vmcnt(14)
    v_mfma_f32_32x32x16_bf16 v[128:143], a[136:139], v[232:235], v[128:143]
    v_mfma_f32_32x32x16_bf16 v[144:159], a[136:139], v[236:239], v[144:159]
    v_mfma_f32_32x32x16_bf16 v[160:175], a[140:143], v[232:235], v[160:175]
    v_mfma_f32_32x32x16_bf16 v[176:191], a[140:143], v[236:239], v[176:191]
    buffer_load_dwordx4 v[72:75], v3, s[44:47], s24 offen offset:1024 sc1
    buffer_load_dwordx4 v[76:79], v3, s[44:47], s25 offen offset:1024 sc1
    s_waitcnt vmcnt(14)
    v_mfma_f32_32x32x16_bf16 v[128:143], a[144:147], v[240:243], v[128:143]
    v_mfma_f32_32x32x16_bf16 v[144:159], a[144:147], v[244:247], v[144:159]
    v_mfma_f32_32x32x16_bf16 v[160:175], a[148:151], v[240:243], v[160:175]
    v_mfma_f32_32x32x16_bf16 v[176:191], a[148:151], v[244:247], v[176:191]
    buffer_load_dwordx4 v[80:83], v3, s[44:47], s24 offen offset:2048 sc1
    buffer_load_dwordx4 v[84:87], v3, s[44:47], s25 offen offset:2048 sc1
    s_waitcnt vmcnt(14)
    v_mfma_f32_32x32x16_bf16 v[128:143], a[152:155], v[248:251], v[128:143]
    v_mfma_f32_32x32x16_bf16 v[144:159], a[152:155], v[252:255], v[144:159]
    v_mfma_f32_32x32x16_bf16 v[160:175], a[156:159], v[248:251], v[160:175]
    v_mfma_f32_32x32x16_bf16 v[176:191], a[156:159], v[252:255], v[176:191]
    buffer_load_dwordx4 v[88:91], v3, s[44:47], s24 offen offset:3072 sc1
    buffer_load_dwordx4 v[92:95], v3, s[44:47], s25 offen offset:3072 sc1
    s_waitcnt vmcnt(14)
    v_mfma_f32_32x32x16_bf16 v[128:143], a[160:163], v[32:35], v[128:143]
    v_mfma_f32_32x32x16_bf16 v[144:159], a[160:163], v[36:39], v[144:159]
    v_mfma_f32_32x32x16_bf16 v[160:175], a[164:167], v[32:35], v[160:175]
    v_mfma_f32_32x32x16_bf16 v[176:191], a[164:167], v[36:39], v[176:191]
    s_waitcnt vmcnt(12)
    v_mfma_f32_32x32x16_bf16 v[128:143], a[168:171], v[40:43], v[128:143]
    v_mfma_f32_32x32x16_bf16 v[144:159], a[168:171], v[44:47], v[144:159]
    v_mfma_f32_32x32x16_bf16 v[160:175], a[172:175], v[40:43], v[160:175]
    v_mfma_f32_32x32x16_bf16 v[176:191], a[172:175], v[44:47], v[176:191]
    s_waitcnt vmcnt(10)
    v_mfma_f32_32x32x16_bf16 v[128:143], a[176:179], v[48:51], v[128:143]
    v_mfma_f32_32x32x16_bf16 v[144:159], a[176:179], v[52:55], v[144:159]
    v_mfma_f32_32x32x16_bf16 v[160:175], a[180:183], v[48:51], v[160:175]
    v_mfma_f32_32x32x16_bf16 v[176:191], a[180:183], v[52:55], v[176:191]
    s_waitcnt vmcnt(8)
    v_mfma_f32_32x32x16_bf16 v[128:143], a[184:187], v[56:59], v[128:143]
    v_mfma_f32_32x32x16_bf16 v[144:159], a[184:187], v[60:63], v[144:159]
    v_mfma_f32_32x32x16_bf16 v[160:175], a[188:191], v[56:59], v[160:175]
    v_mfma_f32_32x32x16_bf16 v[176:191], a[188:191], v[60:63], v[176:191]
    s_waitcnt vmcnt(6)
    v_mfma_f32_32x32x16_bf16 v[128:143], a[192:195], v[64:67], v[128:143]
    v_mfma_f32_32x32x16_bf16 v[144:159], a[192:195], v[68:71], v[144:159]
    v_mfma_f32_32x32x16_bf16 v[160:175], a[196:199], v[64:67], v[160:175]
    v_mfma_f32_32x32x16_bf16 v[176:191], a[196:199], v[68:71], v[176:191]
    s_waitcnt vmcnt(4)
    v_mfma_f32_32x32x16_bf16 v[128:143], a[200:203], v[72:75], v[128:143]
    v_mfma_f32_32x32x16_bf16 v[144:159], a[200:203], v[76:79], v[144:159]
    v_mfma_f32_32x32x16_bf16 v[160:175], a[204:207], v[72:75], v[160:175]
    v_mfma_f32_32x32x16_bf16 v[176:191], a[204:207], v[76:79], v[176:191]
    s_waitcnt vmcnt(2)
    v_mfma_f32_32x32x16_bf16 v[128:143], a[208:211], v[80:83], v[128:143]
    v_mfma_f32_32x32x16_bf16 v[144:159], a[208:211], v[84:87], v[144:159]
    v_mfma_f32_32x32x16_bf16 v[160:175], a[212:215], v[80:83], v[160:175]
    v_mfma_f32_32x32x16_bf16 v[176:191], a[212:215], v[84:87], v[176:191]
    s_waitcnt vmcnt(0)
    v_mfma_f32_32x32x16_bf16 v[128:143], a[216:219], v[88:91], v[128:143]
    v_mfma_f32_32x32x16_bf16 v[144:159], a[216:219], v[92:95], v[144:159]
    v_mfma_f32_32x32x16_bf16 v[160:175], a[220:223], v[88:91], v[160:175]
    v_mfma_f32_32x32x16_bf16 v[176:191], a[220:223], v[92:95], v[176:191]
    s_nop 8
    ds_write_b128 v28, v[128:131] offset:0
    ds_write_b128 v28, v[132:135] offset:32
    ds_write_b128 v28, v[136:139] offset:64
    ds_write_b128 v28, v[140:143] offset:96
    ds_write_b128 v28, v[144:147] offset:8704
    ds_write_b128 v28, v[148:151] offset:8736
    ds_write_b128 v28, v[152:155] offset:8768
    ds_write_b128 v28, v[156:159] offset:8800
    ds_write_b128 v28, v[160:163] offset:128
    ds_write_b128 v28, v[164:167] offset:160
    ds_write_b128 v28, v[168:171] offset:192
    ds_write_b128 v28, v[172:175] offset:224
    s_waitcnt lgkmcnt(6)
    ds_write_b128 v28, v[176:179] offset:8832
    ds_write_b128 v28, v[180:183] offset:8864
    ds_write_b128 v28, v[184:187] offset:8896
    ds_write_b128 v28, v[188:191] offset:8928
    s_waitcnt lgkmcnt(0)
    s_barrier
    ds_read_b64_tr_b16 v[16:17], v9 offset:0
    ds_read_b64_tr_b16 v[18:19], v9 offset:576
    ds_read_b64_tr_b16 v[20:21], v9 offset:4608
    ds_read_b64_tr_b16 v[22:23], v9 offset:5184
    ds_read_b128 v[32:35], v8 offset:0
    ds_read_b128 v[36:39], v8 offset:16
    ds_read_b128 v[40:43], v8 offset:17408
    ds_read_b128 v[44:47], v8 offset:17424
    ds_read_b128 v[48:51], v8 offset:34816
    ds_read_b128 v[52:55], v8 offset:34832
    ds_read_b128 v[56:59], v8 offset:52224
    ds_read_b128 v[60:63], v8 offset:52240
    s_waitcnt lgkmcnt(6)
    ds_read_b128 v[64:67], v8 offset:128
    ds_read_b128 v[68:71], v8 offset:144
    ds_read_b128 v[72:75], v8 offset:17536
    ds_read_b128 v[76:79], v8 offset:17552
    ds_read_b128 v[80:83], v8 offset:34944
    ds_read_b128 v[84:87], v8 offset:34960
    ds_read_b128 v[88:91], v8 offset:52352
    ds_read_b128 v[92:95], v8 offset:52368
    s_waitcnt lgkmcnt(8)
    v_pk_add_f32 v[32:33], v[32:33], v[40:41]
    v_pk_add_f32 v[34:35], v[34:35], v[42:43]
    v_pk_add_f32 v[36:37], v[36:37], v[44:45]
    v_pk_add_f32 v[38:39], v[38:39], v[46:47]
    v_pk_add_f32 v[48:49], v[48:49], v[56:57]
    v_pk_add_f32 v[50:51], v[50:51], v[58:59]
    v_pk_add_f32 v[52:53], v[52:53], v[60:61]
    v_pk_add_f32 v[54:55], v[54:55], v[62:63]
    v_pk_add_f32 v[32:33], v[32:33], v[48:49]
    v_pk_add_f32 v[34:35], v[34:35], v[50:51]
    v_pk_add_f32 v[36:37], v[36:37], v[52:53]
    v_pk_add_f32 v[38:39], v[38:39], v[54:55]
    v_cvt_pk_bf16_f32 v40, v32, v33
    v_cvt_pk_bf16_f32 v42, v34, v35
    v_cvt_pk_bf16_f32 v44, v36, v37
    v_cvt_pk_bf16_f32 v46, v38, v39
    v_lshlrev_b32 v32, 16, v40
    v_lshlrev_b32 v34, 16, v42
    v_lshlrev_b32 v36, 16, v44
    v_lshlrev_b32 v38, 16, v46
    v_and_b32 v33, s51, v40
    v_and_b32 v35, s51, v42
    v_and_b32 v37, s51, v44
    v_and_b32 v39, s51, v46
    v_lshlrev_b32 v48, 16, v16
    v_lshlrev_b32 v50, 16, v17
    v_lshlrev_b32 v52, 16, v18
    v_lshlrev_b32 v54, 16, v19
    v_and_b32 v49, s51, v16
    v_and_b32 v51, s51, v17
    v_and_b32 v53, s51, v18
    v_and_b32 v55, s51, v19
    v_pk_add_f32 v[32:33], v[32:33], v[48:49]
    v_pk_add_f32 v[34:35], v[34:35], v[50:51]
    v_pk_add_f32 v[36:37], v[36:37], v[52:53]
    v_pk_add_f32 v[38:39], v[38:39], v[54:55]
    v_cvt_pk_bf16_f32 v100, v32, v33
    v_cvt_pk_bf16_f32 v101, v34, v35
    v_cvt_pk_bf16_f32 v102, v36, v37
    v_cvt_pk_bf16_f32 v103, v38, v39
    buffer_store_dwordx4 v[100:103], v29, s[68:71], s52 offen offset:0 sc1
    s_waitcnt lgkmcnt(0)
    v_pk_add_f32 v[64:65], v[64:65], v[72:73]
    v_pk_add_f32 v[66:67], v[66:67], v[74:75]
    v_pk_add_f32 v[68:69], v[68:69], v[76:77]
    v_pk_add_f32 v[70:71], v[70:71], v[78:79]
    v_pk_add_f32 v[80:81], v[80:81], v[88:89]
    v_pk_add_f32 v[82:83], v[82:83], v[90:91]
    v_pk_add_f32 v[84:85], v[84:85], v[92:93]
    v_pk_add_f32 v[86:87], v[86:87], v[94:95]
    v_pk_add_f32 v[64:65], v[64:65], v[80:81]
    v_pk_add_f32 v[66:67], v[66:67], v[82:83]
    v_pk_add_f32 v[68:69], v[68:69], v[84:85]
    v_pk_add_f32 v[70:71], v[70:71], v[86:87]
    v_cvt_pk_bf16_f32 v72, v64, v65
    v_cvt_pk_bf16_f32 v74, v66, v67
    v_cvt_pk_bf16_f32 v76, v68, v69
    v_cvt_pk_bf16_f32 v78, v70, v71
    v_lshlrev_b32 v64, 16, v72
    v_lshlrev_b32 v66, 16, v74
    v_lshlrev_b32 v68, 16, v76
    v_lshlrev_b32 v70, 16, v78
    v_and_b32 v65, s51, v72
    v_and_b32 v67, s51, v74
    v_and_b32 v69, s51, v76
    v_and_b32 v71, s51, v78
    v_lshlrev_b32 v80, 16, v20
    v_lshlrev_b32 v82, 16, v21
    v_lshlrev_b32 v84, 16, v22
    v_lshlrev_b32 v86, 16, v23
    v_and_b32 v81, s51, v20
    v_and_b32 v83, s51, v21
    v_and_b32 v85, s51, v22
    v_and_b32 v87, s51, v23
    v_pk_add_f32 v[64:65], v[64:65], v[80:81]
    v_pk_add_f32 v[66:67], v[66:67], v[82:83]
    v_pk_add_f32 v[68:69], v[68:69], v[84:85]
    v_pk_add_f32 v[70:71], v[70:71], v[86:87]
    v_cvt_pk_bf16_f32 v104, v64, v65
    v_cvt_pk_bf16_f32 v105, v66, v67
    v_cvt_pk_bf16_f32 v106, v68, v69
    v_cvt_pk_bf16_f32 v107, v70, v71
    buffer_store_dwordx4 v[104:107], v29, s[68:71], s52 offen offset:64 sc1
    s_endpgm
sequential_preLN__ssm_conv_s4d__geglu_ffn__prompt_kernel_end:
    s_endpgm
sequential_preLN__ssm_conv_s4d__geglu_ffn__prompt_kernel_last:
.section .rodata,"a"
.p2align 6
.amdhsa_kernel sequential_preLN__ssm_conv_s4d__geglu_ffn__prompt_kernel
  .amdhsa_next_free_vgpr 480
  .amdhsa_next_free_sgpr 102
  .amdhsa_accum_offset 256
  .amdhsa_group_segment_fixed_size 0
  .amdhsa_kernarg_size 112
  .amdhsa_user_sgpr_count 2
  .amdhsa_user_sgpr_kernarg_segment_ptr 1
  .amdhsa_system_sgpr_workgroup_id_x 1
  .amdhsa_float_denorm_mode_32 3
  .amdhsa_float_denorm_mode_16_64 3
.end_amdhsa_kernel
```
